```python
import torch

def _softmax(x, axis=-1):
    return torch.softmax(x, dim=axis)
def _gelu(x):
    return torch.nn.functional.gelu(x, approximate="tanh")
def _silu(x):
    return torch.nn.functional.silu(x)
def _sigmoid(x):
    return torch.sigmoid(x)
def _layernorm(x, axis=-1, eps=1e-5):
    m = x.mean(dim=axis, keepdim=True)
    v = x.var(dim=axis, keepdim=True, unbiased=False)
    return (x - m) / torch.sqrt(v + eps)
def _scatter_add(tgt, idx, src, axis=0):
    return tgt.clone().index_add_(axis, idx, src)
def _segment_sum(src, seg, n):
    out = torch.zeros((n,) + src.shape[1:], dtype=src.dtype)
    return out.index_add_(0, seg, src)
def _pad(x, pw):
    flat = tuple(v for pair in reversed(pw) for v in pair)
    return torch.nn.functional.pad(x, flat)

kernel_name = 'concat_heads__gqa_block_cached__gqa_block_cached__decode'

def setup_inputs():

    _w = (lambda a: (lambda t: t.to(torch.bfloat16) if t.is_floating_point() else t)(torch.as_tensor(a)))
    def _A_setup():
        B, Sq, D = 4, 1, 640
        Hq, Hkv, Sk, Dh = 32, 32, 4096, 128
        assert Hq % Hkv == 0, (Hq, Hkv)
        return {
            "x": _w((lambda *s: torch.randn(*s, dtype=torch.bfloat16) * 0.8)(B, Sq, D)),
            "k_cache": _w((lambda *s: torch.randn(*s, dtype=torch.bfloat16) * 0.8)(B, Hkv, Sk, Dh)),
            "v_cache": _w((lambda *s: torch.randn(*s, dtype=torch.bfloat16) * 0.05)(B, Hkv, Sk, Dh)),
            "wq": _w((lambda *s: torch.randn(*s, dtype=torch.bfloat16) * 0.8)(D, Hq * Dh) * (D ** -0.5)),
            "wo": _w((lambda *s: torch.randn(*s, dtype=torch.bfloat16) * 0.05)(Hq * Dh, D) * ((Hq * Dh) ** -0.5)),
        }
    _A_in = _A_setup()

    def _B_setup():
        B, Sq, D = 4, 1, 640
        Hq, Hkv, Sk, Dh = 32, 32, 4096, 128
        assert Hq % Hkv == 0, (Hq, Hkv)
        return {
            "x": _w((lambda *s: torch.randn(*s, dtype=torch.bfloat16) * 0.8)(B, Sq, D)),
            "k_cache": _w((lambda *s: torch.randn(*s, dtype=torch.bfloat16) * 0.8)(B, Hkv, Sk, Dh)),
            "v_cache": _w((lambda *s: torch.randn(*s, dtype=torch.bfloat16) * 0.05)(B, Hkv, Sk, Dh)),
            "wq": _w((lambda *s: torch.randn(*s, dtype=torch.bfloat16) * 0.8)(D, Hq * Dh) * (D ** -0.5)),
            "wo": _w((lambda *s: torch.randn(*s, dtype=torch.bfloat16) * 0.05)(Hq * Dh, D) * ((Hq * Dh) ** -0.5)),
        }
    _B_in = _B_setup()

    return {
        "A_x": _A_in["x"],
        "A_k_cache": _A_in["k_cache"],
        "A_v_cache": _A_in["v_cache"],
        "A_wq": _A_in["wq"],
        "A_wo": _A_in["wo"],
        "B_x": _B_in["x"],
        "B_k_cache": _B_in["k_cache"],
        "B_v_cache": _B_in["v_cache"],
        "B_wq": _B_in["wq"],
        "B_wo": _B_in["wo"],
    }

def reference(A_x, A_k_cache, A_v_cache, A_wq, A_wo, B_x, B_k_cache, B_v_cache, B_wq, B_wo):
    def _A_ref(x, k_cache, v_cache, wq, wo):
        B, Sq, D = x.shape
        Hq, Dh = 32, 128
        Hkv = k_cache.shape[1]
        rep = Hq // Hkv
        q = (lambda x, *d: x.permute(*d))((x @ wq).reshape(B, Sq, Hq, Dh), 0, 2, 1, 3)
        k = (lambda x, n, axis: torch.repeat_interleave(x, n, dim=axis))(k_cache, rep, axis=1)
        v = (lambda x, n, axis: torch.repeat_interleave(x, n, dim=axis))(v_cache, rep, axis=1)
        scores = torch.einsum("bhqd,bhkd->bhqk", q, k) * (Dh ** -0.5)
        p = _softmax(scores, axis=-1)
        o = torch.einsum("bhqk,bhkd->bhqd", p, v)
        return (lambda x, *d: x.permute(*d))(o, 0, 2, 1, 3).reshape(B, Sq, Hq * Dh) @ wo

    def _B_ref(x, k_cache, v_cache, wq, wo):
        B, Sq, D = x.shape
        Hq, Dh = 32, 128
        Hkv = k_cache.shape[1]
        rep = Hq // Hkv
        q = (lambda x, *d: x.permute(*d))((x @ wq).reshape(B, Sq, Hq, Dh), 0, 2, 1, 3)
        k = (lambda x, n, axis: torch.repeat_interleave(x, n, dim=axis))(k_cache, rep, axis=1)
        v = (lambda x, n, axis: torch.repeat_interleave(x, n, dim=axis))(v_cache, rep, axis=1)
        scores = torch.einsum("bhqd,bhkd->bhqk", q, k) * (Dh ** -0.5)
        p = _softmax(scores, axis=-1)
        o = torch.einsum("bhqk,bhkd->bhqd", p, v)
        return (lambda x, *d: x.permute(*d))(o, 0, 2, 1, 3).reshape(B, Sq, Hq * Dh) @ wo

    a = _A_ref(A_x, A_k_cache, A_v_cache, A_wq, A_wo)
    b = _B_ref(B_x, B_k_cache, B_v_cache, B_wq, B_wo)
    return torch.concatenate([a, b], axis=-1)
```

```asm
; @launch grid=(256,1,1) block=(256,1,1) lds=31360
.amdgcn_target "amdgcn-amd-amdhsa--gfx950"
.text
.globl concat_heads__gqa_block_cached__gqa_block_cached__decode_kernel
.p2align 8
.type concat_heads__gqa_block_cached__gqa_block_cached__decode_kernel,@function
concat_heads__gqa_block_cached__gqa_block_cached__decode_kernel:
s_cmp_ge_u32 s2, 256
s_cbranch_scc1 L_end
s_load_dwordx16 s[4:19], s[0:1], 0
s_load_dwordx8 s[20:27], s[0:1], 64
s_load_dwordx2 s[28:29], s[0:1], 96
v_lshrrev_b32 v6, 6, v0
v_and_b32 v1, 63, v0
v_readfirstlane_b32 s30, v6
s_and_b32 s31, s2, 7
s_bfe_u32 s68, s2, 0x20005
s_lshl_b32 s68, s68, 3
s_add_u32 s31, s31, s68
s_lshr_b32 s33, s2, 7
s_bfe_u32 s32, s2, 0x20003
s_lshl_b32 s34, s33, 2
s_add_u32 s34, s34, s32
v_lshrrev_b32 v6, 4, v1
v_and_b32 v7, 15, v1
v_mul_u32_u24 v8, 80, v6
v_lshlrev_b32 v9, 4, v7
v_mul_u32_u24 v3, 327680, v6
v_add_u32 v3, v3, v9
v_lshlrev_b32 v2, 4, v1
v_lshrrev_b32 v120, 2, v7
v_lshlrev_b32 v120, 8, v120
v_lshl_add_u32 v120, v6, 6, v120
v_and_b32 v22, 3, v1
v_lshl_add_u32 v120, v22, 4, v120
v_add_u32 v121, 8192, v120
s_lshl_b32 s68, s32, 5
s_add_u32 s68, s68, s31
s_lshl_b32 s68, s68, 20
s_mul_i32 s69, s32, 1280
s_lshl_b32 s70, s31, 8
s_mul_i32 s73, s30, 2048
s_mov_b32 s67, s73
s_mov_b32 s50, 1280
s_mov_b32 s51, 0x20000
s_sub_u32 s42, 5242880, s70
s_mov_b32 s43, 0x20000
s_mov_b32 s38, 0x100000
s_mov_b32 s39, 0x20000
s_mul_i32 s72, s30, 320
s_mul_i32 s3, s30, 1310720
s_cmp_eq_u32 s33, 0
s_waitcnt lgkmcnt(0)
s_cselect_b64 s[4:5], s[4:5], s[14:15]
s_cselect_b64 s[10:11], s[10:11], s[20:21]
s_cselect_b64 s[6:7], s[6:7], s[16:17]
s_cselect_b64 s[8:9], s[8:9], s[18:19]
s_cselect_b64 s[12:13], s[12:13], s[22:23]
s_add_u32 s48, s4, s69
s_addc_u32 s49, s5, 0
s_add_u32 s40, s10, s70
s_addc_u32 s41, s11, 0
buffer_load_dwordx4 v[80:83], v8, s[48:51], s72 offen offset:0
buffer_load_dwordx4 v[84:87], v8, s[48:51], s72 offen offset:16
buffer_load_dwordx4 v[88:91], v8, s[48:51], s72 offen offset:32
buffer_load_dwordx4 v[92:95], v8, s[48:51], s72 offen offset:48
buffer_load_dwordx4 v[96:99], v8, s[48:51], s72 offen offset:64
s_add_u32 s36, s6, s68
s_addc_u32 s37, s7, 0
s_add_u32 s64, s8, s68
s_addc_u32 s65, s9, 0
s_mov_b32 s14, s67
s_add_u32 s15, s67, 16384
s_add_u32 s16, s67, 32768
s_add_u32 s17, s67, 49152
s_add_u32 s18, s67, 65536
s_add_u32 s19, s67, 81920
s_add_u32 s20, s67, 98304
s_add_u32 s21, s67, 114688
buffer_load_dwordx4 a[0:3], v3, s[40:43], s3 offen nt
s_add_u32 s3, s3, 8192
buffer_load_dwordx4 a[4:7], v3, s[40:43], s3 offen nt
s_add_u32 s3, s3, 8192
buffer_load_dwordx4 v[124:127], v120, s[36:39], s14 offen offset:0 nt
buffer_load_dwordx4 a[8:11], v3, s[40:43], s3 offen nt
s_add_u32 s3, s3, 8192
buffer_load_dwordx4 a[12:15], v3, s[40:43], s3 offen nt
s_add_u32 s3, s3, 8192
buffer_load_dwordx4 v[128:131], v120, s[36:39], s14 offen offset:1024 nt
buffer_load_dwordx4 a[16:19], v3, s[40:43], s3 offen nt
s_add_u32 s3, s3, 8192
buffer_load_dwordx4 a[20:23], v3, s[40:43], s3 offen nt
s_add_u32 s3, s3, 8192
buffer_load_dwordx4 v[132:135], v121, s[36:39], s14 offen offset:0 nt
buffer_load_dwordx4 a[24:27], v3, s[40:43], s3 offen nt
s_add_u32 s3, s3, 8192
buffer_load_dwordx4 a[28:31], v3, s[40:43], s3 offen nt
s_add_u32 s3, s3, 8192
buffer_load_dwordx4 v[136:139], v121, s[36:39], s14 offen offset:1024 nt
buffer_load_dwordx4 a[32:35], v3, s[40:43], s3 offen nt
s_add_u32 s3, s3, 8192
buffer_load_dwordx4 a[36:39], v3, s[40:43], s3 offen nt
s_add_u32 s3, s3, 8192
buffer_load_dwordx4 v[140:143], v120, s[36:39], s15 offen offset:0 nt
buffer_load_dwordx4 a[40:43], v3, s[40:43], s3 offen nt
s_add_u32 s3, s3, 8192
buffer_load_dwordx4 a[44:47], v3, s[40:43], s3 offen nt
s_add_u32 s3, s3, 8192
buffer_load_dwordx4 v[144:147], v120, s[36:39], s15 offen offset:1024 nt
buffer_load_dwordx4 a[48:51], v3, s[40:43], s3 offen nt
s_add_u32 s3, s3, 8192
buffer_load_dwordx4 a[52:55], v3, s[40:43], s3 offen nt
s_add_u32 s3, s3, 8192
buffer_load_dwordx4 v[148:151], v121, s[36:39], s15 offen offset:0 nt
buffer_load_dwordx4 a[56:59], v3, s[40:43], s3 offen nt
s_add_u32 s3, s3, 8192
buffer_load_dwordx4 a[60:63], v3, s[40:43], s3 offen nt
s_add_u32 s3, s3, 8192
buffer_load_dwordx4 v[152:155], v121, s[36:39], s15 offen offset:1024 nt
buffer_load_dwordx4 a[64:67], v3, s[40:43], s3 offen nt
s_add_u32 s3, s3, 8192
buffer_load_dwordx4 a[68:71], v3, s[40:43], s3 offen nt
s_add_u32 s3, s3, 8192
buffer_load_dwordx4 v[156:159], v120, s[36:39], s16 offen offset:0 nt
buffer_load_dwordx4 a[72:75], v3, s[40:43], s3 offen nt
s_add_u32 s3, s3, 8192
buffer_load_dwordx4 a[76:79], v3, s[40:43], s3 offen nt
s_add_u32 s3, s3, 8192
buffer_load_dwordx4 v[160:163], v120, s[36:39], s16 offen offset:1024 nt
buffer_load_dwordx4 a[80:83], v3, s[40:43], s3 offen nt
s_add_u32 s3, s3, 8192
buffer_load_dwordx4 a[84:87], v3, s[40:43], s3 offen nt
s_add_u32 s3, s3, 8192
buffer_load_dwordx4 v[164:167], v121, s[36:39], s16 offen offset:0 nt
buffer_load_dwordx4 a[88:91], v3, s[40:43], s3 offen nt
s_add_u32 s3, s3, 8192
buffer_load_dwordx4 a[92:95], v3, s[40:43], s3 offen nt
s_add_u32 s3, s3, 8192
buffer_load_dwordx4 v[168:171], v121, s[36:39], s16 offen offset:1024 nt
buffer_load_dwordx4 a[96:99], v3, s[40:43], s3 offen nt
s_add_u32 s3, s3, 8192
buffer_load_dwordx4 a[100:103], v3, s[40:43], s3 offen nt
s_add_u32 s3, s3, 8192
buffer_load_dwordx4 v[172:175], v120, s[36:39], s17 offen offset:0 nt
buffer_load_dwordx4 a[104:107], v3, s[40:43], s3 offen nt
s_add_u32 s3, s3, 8192
buffer_load_dwordx4 a[108:111], v3, s[40:43], s3 offen nt
s_add_u32 s3, s3, 8192
buffer_load_dwordx4 v[176:179], v120, s[36:39], s17 offen offset:1024 nt
buffer_load_dwordx4 a[112:115], v3, s[40:43], s3 offen nt
s_add_u32 s3, s3, 8192
buffer_load_dwordx4 a[116:119], v3, s[40:43], s3 offen nt
s_add_u32 s3, s3, 8192
buffer_load_dwordx4 v[180:183], v121, s[36:39], s17 offen offset:0 nt
buffer_load_dwordx4 a[120:123], v3, s[40:43], s3 offen nt
s_add_u32 s3, s3, 8192
buffer_load_dwordx4 a[124:127], v3, s[40:43], s3 offen nt
s_add_u32 s3, s3, 8192
buffer_load_dwordx4 v[184:187], v121, s[36:39], s17 offen offset:1024 nt
buffer_load_dwordx4 a[128:131], v3, s[40:43], s3 offen nt
s_add_u32 s3, s3, 8192
buffer_load_dwordx4 a[132:135], v3, s[40:43], s3 offen nt
s_add_u32 s3, s3, 8192
buffer_load_dwordx4 v[188:191], v120, s[36:39], s18 offen offset:0 nt
buffer_load_dwordx4 a[136:139], v3, s[40:43], s3 offen nt
s_add_u32 s3, s3, 8192
buffer_load_dwordx4 a[140:143], v3, s[40:43], s3 offen nt
s_add_u32 s3, s3, 8192
buffer_load_dwordx4 a[144:147], v3, s[40:43], s3 offen nt
s_add_u32 s3, s3, 8192
buffer_load_dwordx4 a[148:151], v3, s[40:43], s3 offen nt
s_add_u32 s3, s3, 8192
buffer_load_dwordx4 a[152:155], v3, s[40:43], s3 offen nt
s_add_u32 s3, s3, 8192
buffer_load_dwordx4 a[156:159], v3, s[40:43], s3 offen nt
s_lshl_b32 s68, s34, 7
s_add_u32 s68, s68, 655360
s_add_u32 s56, s28, s68
s_addc_u32 s57, s29, 0
s_mov_b32 s58, 4
s_mov_b32 s59, 0x20000
buffer_load_dword v25, off, s[56:59], 0 sc1
s_mul_i32 s68, s31, 163840
s_add_u32 s44, s12, s68
s_addc_u32 s45, s13, 0
s_mov_b32 s46, 163840
s_mov_b32 s47, 0x20000
s_mul_i32 s68, s34, 81920
s_add_u32 s52, s28, s68
s_addc_u32 s53, s29, 0
s_mov_b32 s54, 81920
s_mov_b32 s55, 0x20000
s_mov_b32 s60, s24
s_mov_b32 s61, s25
s_mov_b32 s62, 10240
s_mov_b32 s63, 0x20000
s_cmp_lt_u32 s31, 20
s_cselect_b32 s71, 1, 0
s_cmp_eq_u32 s30, 3
s_cselect_b32 s71, s71, 0
v_mul_u32_u24 v3, 10240, v6
v_add_u32 v3, v3, v9
v_and_b32 v22, 1, v1
v_cmp_eq_u32 vcc, 1, v22
v_mov_b32 v7, 0x0c0c0100
v_mov_b32 v8, 0x01000c0c
v_cndmask_b32 v23, v7, v8, vcc
v_mov_b32 v7, 0x0c0c0302
v_mov_b32 v8, 0x03020c0c
v_cndmask_b32 v24, v7, v8, vcc
v_mov_b32 v7, 0x0c0c0c0c
s_mov_b32 s74, 0x30003
s_mov_b32 s75, 0x30003
s_mov_b32 s76, 0xc000c
s_mov_b32 s77, 0xc000c
s_mov_b32 s78, 0x300030
s_mov_b32 s79, 0x300030
s_mov_b32 s80, 0xc000c0
s_mov_b32 s81, 0xc000c0
v_cndmask_b32 v14, v7, v23, s[74:75]
v_cndmask_b32 v18, v7, v24, s[74:75]
v_cndmask_b32 v15, v7, v23, s[76:77]
v_cndmask_b32 v19, v7, v24, s[76:77]
v_cndmask_b32 v16, v7, v23, s[78:79]
v_cndmask_b32 v20, v7, v24, s[78:79]
v_cndmask_b32 v17, v7, v23, s[80:81]
v_cndmask_b32 v21, v7, v24, s[80:81]
v_mov_b32 v7, 0xffff
s_mov_b32 s74, 0x000f000f
s_mov_b32 s75, 0x000f000f
s_mov_b32 s76, 0x00f000f0
s_mov_b32 s77, 0x00f000f0
v_cndmask_b32 v10, 0, v7, s[74:75]
v_cndmask_b32 v11, 0, v7, s[76:77]
v_and_b32 v12, 3, v1
v_xor_b32 v7, 1, v12
v_lshl_or_b32 v12, v7, 2, v12
v_mul_u32_u24 v12, 0x1111, v12
s_mov_b32 s74, 0x11111111
s_mov_b32 s75, 0x11111111
s_mov_b32 s76, 0x22222222
s_mov_b32 s77, 0x22222222
s_mov_b32 s78, 0x44444444
s_mov_b32 s79, 0x44444444
s_mov_b32 s80, 0x88888888
s_mov_b32 s81, 0x88888888
v_mov_b32 v40, 0
v_mov_b32 v41, 0
v_mov_b32 v42, 0
v_mov_b32 v43, 0
v_accvgpr_write_b32 a160, 0
v_accvgpr_write_b32 a161, 0
v_accvgpr_write_b32 a162, 0
v_accvgpr_write_b32 a163, 0
v_accvgpr_write_b32 a164, 0
v_accvgpr_write_b32 a165, 0
v_accvgpr_write_b32 a166, 0
v_accvgpr_write_b32 a167, 0
v_accvgpr_write_b32 a168, 0
v_accvgpr_write_b32 a169, 0
v_accvgpr_write_b32 a170, 0
v_accvgpr_write_b32 a171, 0
v_accvgpr_write_b32 a172, 0
v_accvgpr_write_b32 a173, 0
v_accvgpr_write_b32 a174, 0
v_accvgpr_write_b32 a175, 0
v_accvgpr_write_b32 a176, 0
v_accvgpr_write_b32 a177, 0
v_accvgpr_write_b32 a178, 0
v_accvgpr_write_b32 a179, 0
v_mov_b32 v23, 0xff800000
v_mov_b32 v24, 0
v_mov_b32 v4, 0x3fb8aa3b
s_lshl_b32 s68, s30, 12
s_add_u32 s68, s68, 14464
v_lshl_add_u32 v26, v1, 2, s68
v_and_b32 v7, 1, v6
v_lshlrev_b32 v7, 1, v7
v_and_b32 v8, 1, v1
v_add_u32 v7, v7, v8
v_lshlrev_b32 v13, 4, v7
v_and_b32 v7, 14, v1
v_add_u32 v13, v13, v7
v_lshrrev_b32 v7, 1, v6
v_add_u32 v13, v13, v7
v_lshl_add_u32 v13, v13, 2, s68
s_lshl_b32 s68, s30, 9
v_lshlrev_b32 v27, 1, v9
v_lshl_add_u32 v27, v6, 4, v27
v_add_u32 v27, s68, v27
v_and_b32 v8, 1, v6
v_lshl_add_u32 v252, v8, 4, v7
v_and_b32 v8, 1, v1
v_lshl_add_u32 v252, v8, 3, v252
v_and_b32 v8, 6, v1
v_add_u32 v252, v252, v8
s_lshl_b32 s68, s30, 7
v_lshl_add_u32 v252, v252, 2, s68
s_lshl_b32 s68, s30, 11
v_add_u32 v253, s68, v27
v_lshlrev_b32 v254, 4, v0
v_lshrrev_b32 v255, 3, v0
v_lshlrev_b32 v255, 12, v255
v_and_b32 v8, 7, v0
v_lshl_add_u32 v255, v8, 4, v255
s_getreg_b32 s68, hwreg(HW_REG_HW_ID)
s_bfe_u32 s100, s68, 0x40008
s_bfe_u32 s68, s68, 0x2000d
s_lshl_b32 s68, s68, 4
s_add_u32 s100, s100, s68
s_lshl_b32 s100, s100, 2
v_lshlrev_b32 v29, 2, v1
s_mov_b32 s35, 0
s_mov_b32 s23, 37
s_getreg_b32 s68, hwreg(HW_REG_XCC_ID)
s_and_b32 s68, s68, 1
s_and_b32 s70, s31, 3
s_cmp_eq_u32 s70, 1
s_cselect_b32 s68, 0, s68
s_mul_i32 s68, s68, 3
s_sub_u32 s23, s23, s68
s_mov_b32 s22, s23
s_mul_i32 s69, s30, 40960
s_waitcnt vmcnt(58)
s_mov_b32 s48, s26
s_mov_b32 s49, s27
s_mov_b32 s50, 256
s_mov_b32 s51, 0x20000
v_perm_b32 v32, v80, v80, v14
v_perm_b32 v33, v80, v80, v15
v_perm_b32 v34, v80, v80, v16
v_perm_b32 v35, v80, v80, v17
v_perm_b32 v36, v80, v80, v18
v_perm_b32 v37, v80, v80, v19
v_perm_b32 v38, v80, v80, v20
v_perm_b32 v39, v80, v80, v21
s_waitcnt vmcnt(57)
v_mfma_f32_16x16x32_bf16 v[60:63], v[32:35], a[0:3], 0
buffer_load_dwordx4 v[192:195], v120, s[36:39], s18 offen offset:1024 nt
v_perm_b32 v32, v81, v81, v14
v_perm_b32 v33, v81, v81, v15
v_perm_b32 v34, v81, v81, v16
v_perm_b32 v35, v81, v81, v17
s_waitcnt vmcnt(57)
v_mfma_f32_16x16x32_bf16 v[60:63], v[36:39], a[4:7], v[60:63]
buffer_load_dwordx4 v[196:199], v121, s[36:39], s18 offen offset:0 nt
v_perm_b32 v36, v81, v81, v18
v_perm_b32 v37, v81, v81, v19
v_perm_b32 v38, v81, v81, v20
v_perm_b32 v39, v81, v81, v21
s_waitcnt vmcnt(56)
v_mfma_f32_16x16x32_bf16 v[60:63], v[32:35], a[8:11], v[60:63]
buffer_load_dwordx4 v[200:203], v121, s[36:39], s18 offen offset:1024 nt
v_perm_b32 v32, v82, v82, v14
v_perm_b32 v33, v82, v82, v15
v_perm_b32 v34, v82, v82, v16
v_perm_b32 v35, v82, v82, v17
s_waitcnt vmcnt(56)
v_mfma_f32_16x16x32_bf16 v[60:63], v[36:39], a[12:15], v[60:63]
buffer_load_dwordx4 v[204:207], v120, s[36:39], s19 offen offset:0 nt
v_perm_b32 v36, v82, v82, v18
v_perm_b32 v37, v82, v82, v19
v_perm_b32 v38, v82, v82, v20
v_perm_b32 v39, v82, v82, v21
s_waitcnt vmcnt(55)
v_mfma_f32_16x16x32_bf16 v[60:63], v[32:35], a[16:19], v[60:63]
buffer_load_dwordx4 v[208:211], v120, s[36:39], s19 offen offset:1024 nt
v_perm_b32 v32, v83, v83, v14
v_perm_b32 v33, v83, v83, v15
v_perm_b32 v34, v83, v83, v16
v_perm_b32 v35, v83, v83, v17
s_waitcnt vmcnt(55)
v_mfma_f32_16x16x32_bf16 v[60:63], v[36:39], a[20:23], v[60:63]
buffer_load_dwordx4 v[212:215], v121, s[36:39], s19 offen offset:0 nt
v_perm_b32 v36, v83, v83, v18
v_perm_b32 v37, v83, v83, v19
v_perm_b32 v38, v83, v83, v20
v_perm_b32 v39, v83, v83, v21
s_waitcnt vmcnt(54)
v_mfma_f32_16x16x32_bf16 v[60:63], v[32:35], a[24:27], v[60:63]
buffer_load_dwordx4 v[216:219], v121, s[36:39], s19 offen offset:1024 nt
v_perm_b32 v32, v84, v84, v14
v_perm_b32 v33, v84, v84, v15
v_perm_b32 v34, v84, v84, v16
v_perm_b32 v35, v84, v84, v17
s_waitcnt vmcnt(54)
v_mfma_f32_16x16x32_bf16 v[60:63], v[36:39], a[28:31], v[60:63]
buffer_load_dwordx4 v[220:223], v120, s[36:39], s20 offen offset:0 nt
v_perm_b32 v36, v84, v84, v18
v_perm_b32 v37, v84, v84, v19
v_perm_b32 v38, v84, v84, v20
v_perm_b32 v39, v84, v84, v21
s_waitcnt vmcnt(53)
v_mfma_f32_16x16x32_bf16 v[60:63], v[32:35], a[32:35], v[60:63]
buffer_load_dwordx4 v[224:227], v120, s[36:39], s20 offen offset:1024 nt
v_perm_b32 v32, v85, v85, v14
v_perm_b32 v33, v85, v85, v15
v_perm_b32 v34, v85, v85, v16
v_perm_b32 v35, v85, v85, v17
s_waitcnt vmcnt(53)
v_mfma_f32_16x16x32_bf16 v[60:63], v[36:39], a[36:39], v[60:63]
buffer_load_dwordx4 v[228:231], v121, s[36:39], s20 offen offset:0 nt
v_perm_b32 v36, v85, v85, v18
v_perm_b32 v37, v85, v85, v19
v_perm_b32 v38, v85, v85, v20
v_perm_b32 v39, v85, v85, v21
s_waitcnt vmcnt(52)
v_mfma_f32_16x16x32_bf16 v[60:63], v[32:35], a[40:43], v[60:63]
buffer_load_dwordx4 v[232:235], v121, s[36:39], s20 offen offset:1024 nt
v_perm_b32 v32, v86, v86, v14
v_perm_b32 v33, v86, v86, v15
v_perm_b32 v34, v86, v86, v16
v_perm_b32 v35, v86, v86, v17
s_waitcnt vmcnt(52)
v_mfma_f32_16x16x32_bf16 v[60:63], v[36:39], a[44:47], v[60:63]
buffer_load_dwordx4 v[236:239], v120, s[36:39], s21 offen offset:0 nt
v_perm_b32 v36, v86, v86, v18
v_perm_b32 v37, v86, v86, v19
v_perm_b32 v38, v86, v86, v20
v_perm_b32 v39, v86, v86, v21
s_waitcnt vmcnt(51)
v_mfma_f32_16x16x32_bf16 v[60:63], v[32:35], a[48:51], v[60:63]
buffer_load_dwordx4 v[240:243], v120, s[36:39], s21 offen offset:1024 nt
v_perm_b32 v32, v87, v87, v14
v_perm_b32 v33, v87, v87, v15
v_perm_b32 v34, v87, v87, v16
v_perm_b32 v35, v87, v87, v17
s_waitcnt vmcnt(51)
v_mfma_f32_16x16x32_bf16 v[60:63], v[36:39], a[52:55], v[60:63]
buffer_load_dwordx4 v[244:247], v121, s[36:39], s21 offen offset:0 nt
v_perm_b32 v36, v87, v87, v18
v_perm_b32 v37, v87, v87, v19
v_perm_b32 v38, v87, v87, v20
v_perm_b32 v39, v87, v87, v21
s_waitcnt vmcnt(50)
v_mfma_f32_16x16x32_bf16 v[60:63], v[32:35], a[56:59], v[60:63]
buffer_load_dwordx4 v[248:251], v121, s[36:39], s21 offen offset:1024 nt
v_perm_b32 v32, v88, v88, v14
v_perm_b32 v33, v88, v88, v15
v_perm_b32 v34, v88, v88, v16
v_perm_b32 v35, v88, v88, v17
s_waitcnt vmcnt(50)
v_mfma_f32_16x16x32_bf16 v[60:63], v[36:39], a[60:63], v[60:63]
v_perm_b32 v36, v88, v88, v18
v_perm_b32 v37, v88, v88, v19
v_perm_b32 v38, v88, v88, v20
v_perm_b32 v39, v88, v88, v21
s_waitcnt vmcnt(48)
v_mfma_f32_16x16x32_bf16 v[60:63], v[32:35], a[64:67], v[60:63]
v_perm_b32 v32, v89, v89, v14
v_perm_b32 v33, v89, v89, v15
v_perm_b32 v34, v89, v89, v16
v_perm_b32 v35, v89, v89, v17
s_waitcnt vmcnt(47)
v_mfma_f32_16x16x32_bf16 v[60:63], v[36:39], a[68:71], v[60:63]
v_perm_b32 v36, v89, v89, v18
v_perm_b32 v37, v89, v89, v19
v_perm_b32 v38, v89, v89, v20
v_perm_b32 v39, v89, v89, v21
s_waitcnt vmcnt(45)
v_mfma_f32_16x16x32_bf16 v[60:63], v[32:35], a[72:75], v[60:63]
v_perm_b32 v32, v90, v90, v14
v_perm_b32 v33, v90, v90, v15
v_perm_b32 v34, v90, v90, v16
v_perm_b32 v35, v90, v90, v17
s_waitcnt vmcnt(44)
v_mfma_f32_16x16x32_bf16 v[60:63], v[36:39], a[76:79], v[60:63]
v_perm_b32 v36, v90, v90, v18
v_perm_b32 v37, v90, v90, v19
v_perm_b32 v38, v90, v90, v20
v_perm_b32 v39, v90, v90, v21
s_waitcnt vmcnt(42)
v_mfma_f32_16x16x32_bf16 v[60:63], v[32:35], a[80:83], v[60:63]
v_perm_b32 v32, v91, v91, v14
v_perm_b32 v33, v91, v91, v15
v_perm_b32 v34, v91, v91, v16
v_perm_b32 v35, v91, v91, v17
s_waitcnt vmcnt(41)
v_mfma_f32_16x16x32_bf16 v[60:63], v[36:39], a[84:87], v[60:63]
v_perm_b32 v36, v91, v91, v18
v_perm_b32 v37, v91, v91, v19
v_perm_b32 v38, v91, v91, v20
v_perm_b32 v39, v91, v91, v21
s_waitcnt vmcnt(39)
v_mfma_f32_16x16x32_bf16 v[60:63], v[32:35], a[88:91], v[60:63]
v_perm_b32 v32, v92, v92, v14
v_perm_b32 v33, v92, v92, v15
v_perm_b32 v34, v92, v92, v16
v_perm_b32 v35, v92, v92, v17
s_waitcnt vmcnt(38)
v_mfma_f32_16x16x32_bf16 v[60:63], v[36:39], a[92:95], v[60:63]
v_perm_b32 v36, v92, v92, v18
v_perm_b32 v37, v92, v92, v19
v_perm_b32 v38, v92, v92, v20
v_perm_b32 v39, v92, v92, v21
s_waitcnt vmcnt(36)
v_mfma_f32_16x16x32_bf16 v[60:63], v[32:35], a[96:99], v[60:63]
v_perm_b32 v32, v93, v93, v14
v_perm_b32 v33, v93, v93, v15
v_perm_b32 v34, v93, v93, v16
v_perm_b32 v35, v93, v93, v17
s_waitcnt vmcnt(35)
v_mfma_f32_16x16x32_bf16 v[60:63], v[36:39], a[100:103], v[60:63]
v_perm_b32 v36, v93, v93, v18
v_perm_b32 v37, v93, v93, v19
v_perm_b32 v38, v93, v93, v20
v_perm_b32 v39, v93, v93, v21
s_waitcnt vmcnt(33)
v_mfma_f32_16x16x32_bf16 v[60:63], v[32:35], a[104:107], v[60:63]
v_perm_b32 v32, v94, v94, v14
v_perm_b32 v33, v94, v94, v15
v_perm_b32 v34, v94, v94, v16
v_perm_b32 v35, v94, v94, v17
s_waitcnt vmcnt(32)
v_mfma_f32_16x16x32_bf16 v[60:63], v[36:39], a[108:111], v[60:63]
v_perm_b32 v36, v94, v94, v18
v_perm_b32 v37, v94, v94, v19
v_perm_b32 v38, v94, v94, v20
v_perm_b32 v39, v94, v94, v21
s_waitcnt vmcnt(30)
v_mfma_f32_16x16x32_bf16 v[60:63], v[32:35], a[112:115], v[60:63]
v_perm_b32 v32, v95, v95, v14
v_perm_b32 v33, v95, v95, v15
v_perm_b32 v34, v95, v95, v16
v_perm_b32 v35, v95, v95, v17
s_waitcnt vmcnt(29)
v_mfma_f32_16x16x32_bf16 v[60:63], v[36:39], a[116:119], v[60:63]
v_perm_b32 v36, v95, v95, v18
v_perm_b32 v37, v95, v95, v19
v_perm_b32 v38, v95, v95, v20
v_perm_b32 v39, v95, v95, v21
s_waitcnt vmcnt(27)
v_mfma_f32_16x16x32_bf16 v[60:63], v[32:35], a[120:123], v[60:63]
v_perm_b32 v32, v96, v96, v14
v_perm_b32 v33, v96, v96, v15
v_perm_b32 v34, v96, v96, v16
v_perm_b32 v35, v96, v96, v17
s_waitcnt vmcnt(26)
v_mfma_f32_16x16x32_bf16 v[60:63], v[36:39], a[124:127], v[60:63]
v_perm_b32 v36, v96, v96, v18
v_perm_b32 v37, v96, v96, v19
v_perm_b32 v38, v96, v96, v20
v_perm_b32 v39, v96, v96, v21
s_waitcnt vmcnt(24)
v_mfma_f32_16x16x32_bf16 v[60:63], v[32:35], a[128:131], v[60:63]
v_perm_b32 v32, v97, v97, v14
v_perm_b32 v33, v97, v97, v15
v_perm_b32 v34, v97, v97, v16
v_perm_b32 v35, v97, v97, v17
s_waitcnt vmcnt(23)
v_mfma_f32_16x16x32_bf16 v[60:63], v[36:39], a[132:135], v[60:63]
v_perm_b32 v36, v97, v97, v18
v_perm_b32 v37, v97, v97, v19
v_perm_b32 v38, v97, v97, v20
v_perm_b32 v39, v97, v97, v21
s_waitcnt vmcnt(21)
v_mfma_f32_16x16x32_bf16 v[60:63], v[32:35], a[136:139], v[60:63]
v_perm_b32 v32, v98, v98, v14
v_perm_b32 v33, v98, v98, v15
v_perm_b32 v34, v98, v98, v16
v_perm_b32 v35, v98, v98, v17
s_waitcnt vmcnt(20)
v_mfma_f32_16x16x32_bf16 v[60:63], v[36:39], a[140:143], v[60:63]
v_perm_b32 v36, v98, v98, v18
v_perm_b32 v37, v98, v98, v19
v_perm_b32 v38, v98, v98, v20
v_perm_b32 v39, v98, v98, v21
s_waitcnt vmcnt(19)
v_mfma_f32_16x16x32_bf16 v[60:63], v[32:35], a[144:147], v[60:63]
v_perm_b32 v32, v99, v99, v14
v_perm_b32 v33, v99, v99, v15
v_perm_b32 v34, v99, v99, v16
v_perm_b32 v35, v99, v99, v17
s_waitcnt vmcnt(18)
v_mfma_f32_16x16x32_bf16 v[60:63], v[36:39], a[148:151], v[60:63]
v_perm_b32 v36, v99, v99, v18
v_perm_b32 v37, v99, v99, v19
v_perm_b32 v38, v99, v99, v20
v_perm_b32 v39, v99, v99, v21
s_waitcnt vmcnt(17)
v_mfma_f32_16x16x32_bf16 v[60:63], v[32:35], a[152:155], v[60:63]
s_nop 1
s_waitcnt vmcnt(16)
v_mfma_f32_16x16x32_bf16 v[60:63], v[36:39], a[156:159], v[60:63]
v_lshrrev_b32 v7, 2, v1
v_lshlrev_b32 v7, 5, v7
s_nop 5
s_mov_b32 exec_hi, 0
ds_write_b128 v27, v[60:63] offset:0
s_mov_b32 exec_hi, -1
s_waitcnt lgkmcnt(0)
s_barrier
ds_read_b128 v[80:83], v7 offset:0
ds_read_b128 v[84:87], v7 offset:16
ds_read_b128 v[88:91], v7 offset:512
ds_read_b128 v[92:95], v7 offset:528
ds_read_b128 v[96:99], v7 offset:1024
ds_read_b128 v[100:103], v7 offset:1040
ds_read_b128 v[104:107], v7 offset:1536
ds_read_b128 v[108:111], v7 offset:1552
s_waitcnt lgkmcnt(4)
v_add_f32 v80, v80, v88
v_add_f32 v81, v81, v89
v_add_f32 v82, v82, v90
v_add_f32 v83, v83, v91
v_add_f32 v84, v84, v92
v_add_f32 v85, v85, v93
v_add_f32 v86, v86, v94
v_add_f32 v87, v87, v95
s_waitcnt lgkmcnt(0)
v_add_f32 v96, v96, v104
v_add_f32 v97, v97, v105
v_add_f32 v98, v98, v106
v_add_f32 v99, v99, v107
v_add_f32 v100, v100, v108
v_add_f32 v101, v101, v109
v_add_f32 v102, v102, v110
v_add_f32 v103, v103, v111
v_add_f32 v80, v80, v96
v_add_f32 v81, v81, v97
v_add_f32 v82, v82, v98
v_add_f32 v83, v83, v99
v_add_f32 v84, v84, v100
v_add_f32 v85, v85, v101
v_add_f32 v86, v86, v102
v_add_f32 v87, v87, v103
v_cvt_pk_bf16_f32 v88, v80, v81
v_cvt_pk_bf16_f32 v89, v82, v83
v_cvt_pk_bf16_f32 v90, v84, v85
v_cvt_pk_bf16_f32 v91, v86, v87
v_cndmask_b32 v44, 0, v88, s[74:75]
v_cndmask_b32 v45, 0, v89, s[74:75]
v_cndmask_b32 v46, 0, v90, s[74:75]
v_cndmask_b32 v47, 0, v91, s[74:75]
v_cndmask_b32 v48, 0, v88, s[76:77]
v_cndmask_b32 v49, 0, v89, s[76:77]
v_cndmask_b32 v50, 0, v90, s[76:77]
v_cndmask_b32 v51, 0, v91, s[76:77]
v_cndmask_b32 v52, 0, v88, s[78:79]
v_cndmask_b32 v53, 0, v89, s[78:79]
v_cndmask_b32 v54, 0, v90, s[78:79]
v_cndmask_b32 v55, 0, v91, s[78:79]
v_cndmask_b32 v56, 0, v88, s[80:81]
v_cndmask_b32 v57, 0, v89, s[80:81]
v_cndmask_b32 v58, 0, v90, s[80:81]
v_cndmask_b32 v59, 0, v91, s[80:81]
s_mov_b32 s66, 0
L_k:
s_add_u32 s67, s67, 131072
s_bitcmp1_b32 s66, 2
s_cbranch_scc1 L_k_wo4_2
s_bitcmp1_b32 s66, 1
s_cbranch_scc1 L_k_wo2_1
s_bitcmp1_b32 s66, 0
s_cbranch_scc1 L_k_wo1_0
buffer_load_dwordx4 a[0:3], v3, s[44:47], s69 offen offset:0 nt
buffer_load_dwordx4 a[8:11], v3, s[44:47], s69 offen offset:256 nt
buffer_load_dwordx4 a[16:19], v3, s[44:47], s69 offen offset:512 nt
buffer_load_dwordx4 a[24:27], v3, s[44:47], s69 offen offset:768 nt
buffer_load_dwordx4 a[32:35], v3, s[44:47], s69 offen offset:1024 nt
s_branch L_k_wodone
L_k_wo1_0:
buffer_load_dwordx4 a[4:7], v3, s[44:47], s69 offen offset:0 nt
buffer_load_dwordx4 a[12:15], v3, s[44:47], s69 offen offset:256 nt
buffer_load_dwordx4 a[20:23], v3, s[44:47], s69 offen offset:512 nt
buffer_load_dwordx4 a[28:31], v3, s[44:47], s69 offen offset:768 nt
buffer_load_dwordx4 a[36:39], v3, s[44:47], s69 offen offset:1024 nt
s_branch L_k_wodone
L_k_wo2_1:
s_bitcmp1_b32 s66, 0
s_cbranch_scc1 L_k_wo3_0
buffer_load_dwordx4 a[40:43], v3, s[44:47], s69 offen offset:0 nt
buffer_load_dwordx4 a[48:51], v3, s[44:47], s69 offen offset:256 nt
buffer_load_dwordx4 a[56:59], v3, s[44:47], s69 offen offset:512 nt
buffer_load_dwordx4 a[64:67], v3, s[44:47], s69 offen offset:768 nt
buffer_load_dwordx4 a[72:75], v3, s[44:47], s69 offen offset:1024 nt
s_branch L_k_wodone
L_k_wo3_0:
buffer_load_dwordx4 a[44:47], v3, s[44:47], s69 offen offset:0 nt
buffer_load_dwordx4 a[52:55], v3, s[44:47], s69 offen offset:256 nt
buffer_load_dwordx4 a[60:63], v3, s[44:47], s69 offen offset:512 nt
buffer_load_dwordx4 a[68:71], v3, s[44:47], s69 offen offset:768 nt
buffer_load_dwordx4 a[76:79], v3, s[44:47], s69 offen offset:1024 nt
s_branch L_k_wodone
L_k_wo4_2:
s_bitcmp1_b32 s66, 1
s_cbranch_scc1 L_k_wo6_1
s_bitcmp1_b32 s66, 0
s_cbranch_scc1 L_k_wo5_0
buffer_load_dwordx4 a[80:83], v3, s[44:47], s69 offen offset:0 nt
buffer_load_dwordx4 a[88:91], v3, s[44:47], s69 offen offset:256 nt
buffer_load_dwordx4 a[96:99], v3, s[44:47], s69 offen offset:512 nt
buffer_load_dwordx4 a[104:107], v3, s[44:47], s69 offen offset:768 nt
buffer_load_dwordx4 a[112:115], v3, s[44:47], s69 offen offset:1024 nt
s_branch L_k_wodone
L_k_wo5_0:
buffer_load_dwordx4 a[84:87], v3, s[44:47], s69 offen offset:0 nt
buffer_load_dwordx4 a[92:95], v3, s[44:47], s69 offen offset:256 nt
buffer_load_dwordx4 a[100:103], v3, s[44:47], s69 offen offset:512 nt
buffer_load_dwordx4 a[108:111], v3, s[44:47], s69 offen offset:768 nt
buffer_load_dwordx4 a[116:119], v3, s[44:47], s69 offen offset:1024 nt
s_branch L_k_wodone
L_k_wo6_1:
s_bitcmp1_b32 s66, 0
s_cbranch_scc1 L_k_wo7_0
buffer_load_dwordx4 a[120:123], v3, s[44:47], s69 offen offset:0 nt
buffer_load_dwordx4 a[128:131], v3, s[44:47], s69 offen offset:256 nt
buffer_load_dwordx4 a[136:139], v3, s[44:47], s69 offen offset:512 nt
buffer_load_dwordx4 a[144:147], v3, s[44:47], s69 offen offset:768 nt
buffer_load_dwordx4 a[152:155], v3, s[44:47], s69 offen offset:1024 nt
s_branch L_k_wodone
L_k_wo7_0:
buffer_load_dwordx4 a[124:127], v3, s[44:47], s69 offen offset:0 nt
buffer_load_dwordx4 a[132:135], v3, s[44:47], s69 offen offset:256 nt
buffer_load_dwordx4 a[140:143], v3, s[44:47], s69 offen offset:512 nt
buffer_load_dwordx4 a[148:151], v3, s[44:47], s69 offen offset:768 nt
buffer_load_dwordx4 a[156:159], v3, s[44:47], s69 offen offset:1024 nt
L_k_wodone:
s_add_u32 s69, s69, 1280
s_cmp_lg_u32 s66, 7
s_cbranch_scc1 L_k_go
s_mov_b32 s36, s64
s_mov_b32 s37, s65
s_mov_b32 s67, s73
v_mov_b32 v120, v2
v_add_u32 v121, 8192, v2
L_k_go:
s_mov_b32 s14, s67
s_add_u32 s15, s67, 16384
s_add_u32 s16, s67, 32768
s_add_u32 s17, s67, 49152
s_add_u32 s18, s67, 65536
s_add_u32 s19, s67, 81920
s_add_u32 s20, s67, 98304
s_add_u32 s21, s67, 114688
s_add_u32 s66, s66, 1
buffer_load_dword v28, v29, s[48:51], 0 offen sc1
L_k_nord:
s_waitcnt vmcnt(10)
s_cmp_gt_u32 s22, 32
s_cbranch_scc1 L_k_w0
s_waitcnt vmcnt(9)
L_k_w0:
v_mfma_f32_16x16x32_bf16 v[60:63], v[124:127], v[44:47], 0
buffer_load_dwordx4 v[124:127], v120, s[36:39], s14 offen offset:0 nt
s_waitcnt vmcnt(9)
v_mfma_f32_16x16x32_bf16 v[60:63], v[128:131], v[48:51], v[60:63]
buffer_load_dwordx4 v[128:131], v120, s[36:39], s14 offen offset:1024 nt
s_waitcnt vmcnt(10)
s_cmp_gt_u32 s22, 40
s_cbranch_scc1 L_k_w2
s_waitcnt vmcnt(9)
L_k_w2:
v_mfma_f32_16x16x32_bf16 v[60:63], v[132:135], v[52:55], v[60:63]
buffer_load_dwordx4 v[132:135], v121, s[36:39], s14 offen offset:0 nt
s_waitcnt vmcnt(9)
s_cmp_gt_u32 s22, 24
s_cbranch_scc1 L_k_w3
s_waitcnt vmcnt(8)
L_k_w3:
v_mfma_f32_16x16x32_bf16 v[60:63], v[136:139], v[56:59], v[60:63]
buffer_load_dwordx4 v[136:139], v121, s[36:39], s14 offen offset:1024 nt
s_waitcnt vmcnt(10)
s_cmp_gt_u32 s22, 36
s_cbranch_scc1 L_k_w4
s_waitcnt vmcnt(9)
L_k_w4:
v_mfma_f32_16x16x32_bf16 v[64:67], v[140:143], v[44:47], 0
buffer_load_dwordx4 v[140:143], v120, s[36:39], s15 offen offset:0 nt
s_waitcnt vmcnt(4)
v_mfma_f32_16x16x32_bf16 v[64:67], v[144:147], v[48:51], v[64:67]
buffer_load_dwordx4 v[144:147], v120, s[36:39], s15 offen offset:1024 nt
s_waitcnt vmcnt(5)
s_cmp_gt_u32 s22, 44
s_cbranch_scc1 L_k_w6
s_waitcnt vmcnt(4)
L_k_w6:
v_mfma_f32_16x16x32_bf16 v[64:67], v[148:151], v[52:55], v[64:67]
buffer_load_dwordx4 v[148:151], v121, s[36:39], s15 offen offset:0 nt
s_waitcnt vmcnt(4)
s_cmp_gt_u32 s22, 28
s_cbranch_scc1 L_k_w7
s_waitcnt vmcnt(3)
L_k_w7:
v_mfma_f32_16x16x32_bf16 v[64:67], v[152:155], v[56:59], v[64:67]
buffer_load_dwordx4 v[152:155], v121, s[36:39], s15 offen offset:1024 nt
s_cmp_lg_u32 s30, 0
s_cbranch_scc1 L_k_np0
s_add_u32 s68, s35, 1
v_mov_b32 v30, s68
s_mov_b64 exec, 1
buffer_store_dword v30, off, s[48:51], s100
s_mov_b64 exec, -1
L_k_np0:
s_waitcnt vmcnt(5)
s_cmp_gt_u32 s22, 34
s_cbranch_scc1 L_k_w8
s_waitcnt vmcnt(4)
L_k_w8:
v_mfma_f32_16x16x32_bf16 v[68:71], v[156:159], v[44:47], 0
buffer_load_dwordx4 v[156:159], v120, s[36:39], s16 offen offset:0 nt
s_waitcnt vmcnt(4)
v_mfma_f32_16x16x32_bf16 v[68:71], v[160:163], v[48:51], v[68:71]
buffer_load_dwordx4 v[160:163], v120, s[36:39], s16 offen offset:1024 nt
s_waitcnt vmcnt(5)
s_cmp_gt_u32 s22, 42
s_cbranch_scc1 L_k_w10
s_waitcnt vmcnt(4)
L_k_w10:
v_mfma_f32_16x16x32_bf16 v[68:71], v[164:167], v[52:55], v[68:71]
buffer_load_dwordx4 v[164:167], v121, s[36:39], s16 offen offset:0 nt
s_waitcnt vmcnt(4)
s_cmp_gt_u32 s22, 26
s_cbranch_scc1 L_k_w11
s_waitcnt vmcnt(3)
L_k_w11:
v_mfma_f32_16x16x32_bf16 v[68:71], v[168:171], v[56:59], v[68:71]
buffer_load_dwordx4 v[168:171], v121, s[36:39], s16 offen offset:1024 nt
s_waitcnt vmcnt(5)
s_cmp_gt_u32 s22, 38
s_cbranch_scc1 L_k_w12
s_waitcnt vmcnt(4)
L_k_w12:
v_mfma_f32_16x16x32_bf16 v[72:75], v[172:175], v[44:47], 0
buffer_load_dwordx4 v[172:175], v120, s[36:39], s17 offen offset:0 nt
s_waitcnt vmcnt(4)
v_mfma_f32_16x16x32_bf16 v[72:75], v[176:179], v[48:51], v[72:75]
buffer_load_dwordx4 v[176:179], v120, s[36:39], s17 offen offset:1024 nt
s_waitcnt vmcnt(5)
s_cmp_gt_u32 s22, 46
s_cbranch_scc1 L_k_w14
s_waitcnt vmcnt(4)
L_k_w14:
v_mfma_f32_16x16x32_bf16 v[72:75], v[180:183], v[52:55], v[72:75]
buffer_load_dwordx4 v[180:183], v121, s[36:39], s17 offen offset:0 nt
s_waitcnt vmcnt(4)
s_cmp_gt_u32 s22, 30
s_cbranch_scc1 L_k_w15
s_waitcnt vmcnt(3)
L_k_w15:
v_mfma_f32_16x16x32_bf16 v[72:75], v[184:187], v[56:59], v[72:75]
buffer_load_dwordx4 v[184:187], v121, s[36:39], s17 offen offset:1024 nt
s_cmp_lg_u32 s30, 1
s_cbranch_scc1 L_k_np1
s_add_u32 s68, s35, 2
v_mov_b32 v30, s68
s_mov_b64 exec, 1
buffer_store_dword v30, off, s[48:51], s100
s_mov_b64 exec, -1
L_k_np1:
v_mov_b32_dpp v22, v60 quad_perm:[0,1,2,3] row_mask:0xf bank_mask:0x1
v_add_f32_dpp v22, v61, v22 row_ror:12 row_mask:0xf bank_mask:0x1
v_add_f32_dpp v22, v62, v22 row_ror:8 row_mask:0xf bank_mask:0x1
v_add_f32_dpp v22, v63, v22 row_ror:4 row_mask:0xf bank_mask:0x1
v_mov_b32_dpp v22, v65 quad_perm:[0,1,2,3] row_mask:0xf bank_mask:0x2
v_add_f32_dpp v22, v66, v22 row_ror:12 row_mask:0xf bank_mask:0x2
v_add_f32_dpp v22, v67, v22 row_ror:8 row_mask:0xf bank_mask:0x2
v_add_f32_dpp v22, v64, v22 row_ror:4 row_mask:0xf bank_mask:0x2
v_mov_b32_dpp v22, v70 quad_perm:[0,1,2,3] row_mask:0xf bank_mask:0x4
v_add_f32_dpp v22, v71, v22 row_ror:12 row_mask:0xf bank_mask:0x4
v_add_f32_dpp v22, v68, v22 row_ror:8 row_mask:0xf bank_mask:0x4
v_add_f32_dpp v22, v69, v22 row_ror:4 row_mask:0xf bank_mask:0x4
v_mov_b32_dpp v22, v75 quad_perm:[0,1,2,3] row_mask:0xf bank_mask:0x8
v_add_f32_dpp v22, v72, v22 row_ror:12 row_mask:0xf bank_mask:0x8
v_add_f32_dpp v22, v73, v22 row_ror:8 row_mask:0xf bank_mask:0x8
v_add_f32_dpp v22, v74, v22 row_ror:4 row_mask:0xf bank_mask:0x8
v_cvt_pk_bf16_f32 v22, v22, v22
v_lshlrev_b32 v22, 16, v22
v_mul_f32 v22, 0x3db504f3, v22
v_cvt_pk_bf16_f32 v22, v22, v22
v_lshlrev_b32 v22, 16, v22
v_max_f32 v23, v23, v22
ds_write_b32 v26, v22 offset:0
v_add_u32_dpp v28, v28, v28 row_ror:8 row_mask:0xf bank_mask:0xf
s_nop 1
v_add_u32_dpp v28, v28, v28 row_ror:4 row_mask:0xf bank_mask:0xf
s_nop 1
v_add_u32_dpp v28, v28, v28 row_ror:2 row_mask:0xf bank_mask:0xf
s_nop 1
v_add_u32_dpp v28, v28, v28 row_ror:1 row_mask:0xf bank_mask:0xf
s_nop 0
v_readlane_b32 s68, v28, 0
v_readlane_b32 s70, v28, 16
v_readlane_b32 s98, v28, 32
v_readlane_b32 s99, v28, 48
s_add_u32 s68, s68, s70
s_add_u32 s98, s98, s99
s_add_u32 s68, s68, s98
s_lshl_b32 s70, s35, 5
s_sub_i32 s68, s68, s70
s_add_i32 s68, s68, 21
s_ashr_i32 s68, s68, 1
s_add_i32 s68, s68, s23
s_max_i32 s68, s68, 24
s_min_i32 s22, s68, 48
L_k_noup:
s_add_u32 s35, s35, 4
s_waitcnt vmcnt(5)
s_cmp_gt_u32 s22, 33
s_cbranch_scc1 L_k_w16
s_waitcnt vmcnt(4)
L_k_w16:
v_mfma_f32_16x16x32_bf16 v[60:63], v[188:191], v[44:47], 0
buffer_load_dwordx4 v[188:191], v120, s[36:39], s18 offen offset:0 nt
s_waitcnt vmcnt(4)
v_mfma_f32_16x16x32_bf16 v[60:63], v[192:195], v[48:51], v[60:63]
buffer_load_dwordx4 v[192:195], v120, s[36:39], s18 offen offset:1024 nt
s_waitcnt vmcnt(5)
s_cmp_gt_u32 s22, 41
s_cbranch_scc1 L_k_w18
s_waitcnt vmcnt(4)
L_k_w18:
v_mfma_f32_16x16x32_bf16 v[60:63], v[196:199], v[52:55], v[60:63]
buffer_load_dwordx4 v[196:199], v121, s[36:39], s18 offen offset:0 nt
s_waitcnt vmcnt(4)
s_cmp_gt_u32 s22, 25
s_cbranch_scc1 L_k_w19
s_waitcnt vmcnt(3)
L_k_w19:
v_mfma_f32_16x16x32_bf16 v[60:63], v[200:203], v[56:59], v[60:63]
buffer_load_dwordx4 v[200:203], v121, s[36:39], s18 offen offset:1024 nt
s_waitcnt vmcnt(5)
s_cmp_gt_u32 s22, 37
s_cbranch_scc1 L_k_w20
s_waitcnt vmcnt(4)
L_k_w20:
v_mfma_f32_16x16x32_bf16 v[64:67], v[204:207], v[44:47], 0
buffer_load_dwordx4 v[204:207], v120, s[36:39], s19 offen offset:0 nt
s_waitcnt vmcnt(4)
v_mfma_f32_16x16x32_bf16 v[64:67], v[208:211], v[48:51], v[64:67]
buffer_load_dwordx4 v[208:211], v120, s[36:39], s19 offen offset:1024 nt
s_waitcnt vmcnt(5)
s_cmp_gt_u32 s22, 45
s_cbranch_scc1 L_k_w22
s_waitcnt vmcnt(4)
L_k_w22:
v_mfma_f32_16x16x32_bf16 v[64:67], v[212:215], v[52:55], v[64:67]
buffer_load_dwordx4 v[212:215], v121, s[36:39], s19 offen offset:0 nt
s_waitcnt vmcnt(4)
s_cmp_gt_u32 s22, 29
s_cbranch_scc1 L_k_w23
s_waitcnt vmcnt(3)
L_k_w23:
v_mfma_f32_16x16x32_bf16 v[64:67], v[216:219], v[56:59], v[64:67]
buffer_load_dwordx4 v[216:219], v121, s[36:39], s19 offen offset:1024 nt
s_cmp_lg_u32 s30, 2
s_cbranch_scc1 L_k_np2
s_add_u32 s68, s35, -1
v_mov_b32 v30, s68
s_mov_b64 exec, 1
buffer_store_dword v30, off, s[48:51], s100
s_mov_b64 exec, -1
L_k_np2:
s_waitcnt vmcnt(5)
s_cmp_gt_u32 s22, 35
s_cbranch_scc1 L_k_w24
s_waitcnt vmcnt(4)
L_k_w24:
v_mfma_f32_16x16x32_bf16 v[68:71], v[220:223], v[44:47], 0
buffer_load_dwordx4 v[220:223], v120, s[36:39], s20 offen offset:0 nt
s_waitcnt vmcnt(4)
v_mfma_f32_16x16x32_bf16 v[68:71], v[224:227], v[48:51], v[68:71]
buffer_load_dwordx4 v[224:227], v120, s[36:39], s20 offen offset:1024 nt
s_waitcnt vmcnt(5)
s_cmp_gt_u32 s22, 43
s_cbranch_scc1 L_k_w26
s_waitcnt vmcnt(4)
L_k_w26:
v_mfma_f32_16x16x32_bf16 v[68:71], v[228:231], v[52:55], v[68:71]
buffer_load_dwordx4 v[228:231], v121, s[36:39], s20 offen offset:0 nt
s_waitcnt vmcnt(4)
s_cmp_gt_u32 s22, 27
s_cbranch_scc1 L_k_w27
s_waitcnt vmcnt(3)
L_k_w27:
v_mfma_f32_16x16x32_bf16 v[68:71], v[232:235], v[56:59], v[68:71]
buffer_load_dwordx4 v[232:235], v121, s[36:39], s20 offen offset:1024 nt
s_waitcnt vmcnt(5)
s_cmp_gt_u32 s22, 39
s_cbranch_scc1 L_k_w28
s_waitcnt vmcnt(4)
L_k_w28:
v_mfma_f32_16x16x32_bf16 v[72:75], v[236:239], v[44:47], 0
buffer_load_dwordx4 v[236:239], v120, s[36:39], s21 offen offset:0 nt
s_waitcnt vmcnt(4)
v_mfma_f32_16x16x32_bf16 v[72:75], v[240:243], v[48:51], v[72:75]
buffer_load_dwordx4 v[240:243], v120, s[36:39], s21 offen offset:1024 nt
s_waitcnt vmcnt(5)
s_cmp_gt_u32 s22, 47
s_cbranch_scc1 L_k_w30
s_waitcnt vmcnt(4)
L_k_w30:
v_mfma_f32_16x16x32_bf16 v[72:75], v[244:247], v[52:55], v[72:75]
buffer_load_dwordx4 v[244:247], v121, s[36:39], s21 offen offset:0 nt
s_waitcnt vmcnt(4)
s_cmp_gt_u32 s22, 31
s_cbranch_scc1 L_k_w31
s_waitcnt vmcnt(3)
L_k_w31:
v_mfma_f32_16x16x32_bf16 v[72:75], v[248:251], v[56:59], v[72:75]
buffer_load_dwordx4 v[248:251], v121, s[36:39], s21 offen offset:1024 nt
s_cmp_lg_u32 s30, 3
s_cbranch_scc1 L_k_np3
s_add_u32 s68, s35, 0
v_mov_b32 v30, s68
s_mov_b64 exec, 1
buffer_store_dword v30, off, s[48:51], s100
s_mov_b64 exec, -1
L_k_np3:
v_mov_b32_dpp v22, v60 quad_perm:[0,1,2,3] row_mask:0xf bank_mask:0x1
v_add_f32_dpp v22, v61, v22 row_ror:12 row_mask:0xf bank_mask:0x1
v_add_f32_dpp v22, v62, v22 row_ror:8 row_mask:0xf bank_mask:0x1
v_add_f32_dpp v22, v63, v22 row_ror:4 row_mask:0xf bank_mask:0x1
v_mov_b32_dpp v22, v65 quad_perm:[0,1,2,3] row_mask:0xf bank_mask:0x2
v_add_f32_dpp v22, v66, v22 row_ror:12 row_mask:0xf bank_mask:0x2
v_add_f32_dpp v22, v67, v22 row_ror:8 row_mask:0xf bank_mask:0x2
v_add_f32_dpp v22, v64, v22 row_ror:4 row_mask:0xf bank_mask:0x2
v_mov_b32_dpp v22, v70 quad_perm:[0,1,2,3] row_mask:0xf bank_mask:0x4
v_add_f32_dpp v22, v71, v22 row_ror:12 row_mask:0xf bank_mask:0x4
v_add_f32_dpp v22, v68, v22 row_ror:8 row_mask:0xf bank_mask:0x4
v_add_f32_dpp v22, v69, v22 row_ror:4 row_mask:0xf bank_mask:0x4
v_mov_b32_dpp v22, v75 quad_perm:[0,1,2,3] row_mask:0xf bank_mask:0x8
v_add_f32_dpp v22, v72, v22 row_ror:12 row_mask:0xf bank_mask:0x8
v_add_f32_dpp v22, v73, v22 row_ror:8 row_mask:0xf bank_mask:0x8
v_add_f32_dpp v22, v74, v22 row_ror:4 row_mask:0xf bank_mask:0x8
v_cvt_pk_bf16_f32 v22, v22, v22
v_lshlrev_b32 v22, 16, v22
v_mul_f32 v22, 0x3db504f3, v22
v_cvt_pk_bf16_f32 v22, v22, v22
v_lshlrev_b32 v22, 16, v22
v_max_f32 v23, v23, v22
ds_write_b32 v26, v22 offset:256
v_add_u32 v26, 512, v26
s_cmp_lt_u32 s66, 8
s_cbranch_scc1 L_k
ds_read_b32 v48, v13 offset:0
ds_read_b32 v49, v13 offset:256
v_max_f32_dpp v23, v23, v23 row_ror:8 row_mask:0xf bank_mask:0xf
s_nop 1
v_max_f32_dpp v23, v23, v23 row_ror:4 row_mask:0xf bank_mask:0xf
s_nop 1
v_max_f32_dpp v23, v23, v23 row_ror:2 row_mask:0xf bank_mask:0xf
s_nop 1
v_max_f32_dpp v23, v23, v23 row_ror:1 row_mask:0xf bank_mask:0xf
s_nop 0
v_mov_b32 v6, v23
s_nop 1
v_permlane16_swap_b32 v23, v6
s_nop 0
v_max_f32 v23, v23, v6
v_mov_b32 v6, v23
s_nop 1
v_permlane32_swap_b32 v23, v6
s_nop 0
v_max_f32 v23, v23, v6
v_mul_f32 v5, v23, v4
v_add_u32 v25, 0x01010101, v25
v_bfe_u32 v52, v25, 0, 8
v_bfe_u32 v53, v25, 8, 8
v_bfe_u32 v54, v25, 16, 8
v_bfe_u32 v55, v25, 24, 8
s_lshl_b32 s69, s31, 7
s_waitcnt lgkmcnt(0)
v_fma_f32 v6, v48, v4, -v5
v_fma_f32 v7, v49, v4, -v5
v_add_u32 v13, 512, v13
v_exp_f32 v6, v6
v_exp_f32 v7, v7
ds_read_b32 v48, v13 offset:0
ds_read_b32 v49, v13 offset:256
v_cvt_pk_bf16_f32 v46, v6, v6
v_cvt_pk_bf16_f32 v47, v7, v7
v_add_f32 v24, v24, v6
v_add_f32 v24, v24, v7
s_mov_b32 s66, 0
L_va:
s_add_u32 s67, s67, 131072
s_waitcnt lgkmcnt(0)
v_mov_b32 v44, v46
v_mov_b32 v45, v47
v_fma_f32 v6, v48, v4, -v5
v_fma_f32 v7, v49, v4, -v5
v_add_u32 v13, 512, v13
v_exp_f32 v6, v6
v_exp_f32 v7, v7
ds_read_b32 v48, v13 offset:0
ds_read_b32 v49, v13 offset:256
v_cvt_pk_bf16_f32 v46, v6, v6
v_cvt_pk_bf16_f32 v47, v7, v7
v_add_f32 v24, v24, v6
v_add_f32 v24, v24, v7
s_mov_b32 s14, s67
s_add_u32 s15, s67, 16384
s_add_u32 s16, s67, 32768
s_add_u32 s17, s67, 49152
s_add_u32 s18, s67, 65536
s_add_u32 s19, s67, 81920
s_add_u32 s20, s67, 98304
s_add_u32 s21, s67, 114688
s_add_u32 s66, s66, 1
s_cmp_lg_u32 s66, 7
s_cbranch_scc1 L_va_go
v_add_f32_dpp v24, v24, v24 row_ror:8 row_mask:0xf bank_mask:0xf
s_nop 1
v_add_f32_dpp v24, v24, v24 row_ror:4 row_mask:0xf bank_mask:0xf
s_nop 1
v_add_f32_dpp v24, v24, v24 row_ror:2 row_mask:0xf bank_mask:0xf
s_nop 1
v_add_f32_dpp v24, v24, v24 row_ror:1 row_mask:0xf bank_mask:0xf
s_nop 0
v_mov_b32 v6, v24
s_nop 1
v_permlane16_swap_b32 v24, v6
s_nop 0
v_add_f32 v24, v24, v6
v_mov_b32 v6, v24
s_nop 1
v_permlane32_swap_b32 v24, v6
s_nop 0
v_add_f32 v24, v24, v6
s_lshl_b32 s68, s30, 3
v_mov_b32 v8, v5
v_mov_b32 v9, v24
v_mov_b32 v7, s68
ds_write_b64 v7, v[8:9] offset:4096
L_va_go:
v_and_b32_dpp v32, v44, v10 row_newbcast:0 row_mask:0xf bank_mask:0xf
v_and_b32_dpp v33, v44, v11 row_newbcast:0 row_mask:0xf bank_mask:0xf
v_and_b32_dpp v34, v44, v10 row_newbcast:1 row_mask:0xf bank_mask:0xf
v_and_b32_dpp v35, v44, v11 row_newbcast:1 row_mask:0xf bank_mask:0xf
v_and_b32_dpp v36, v44, v10 row_newbcast:2 row_mask:0xf bank_mask:0xf
v_and_b32_dpp v37, v44, v11 row_newbcast:2 row_mask:0xf bank_mask:0xf
v_and_b32_dpp v38, v44, v10 row_newbcast:3 row_mask:0xf bank_mask:0xf
v_and_b32_dpp v39, v44, v11 row_newbcast:3 row_mask:0xf bank_mask:0xf
buffer_load_dword v28, v29, s[48:51], 0 offen sc1
L_va_nord:
s_waitcnt vmcnt(5)
s_cmp_gt_u32 s22, 32
s_cbranch_scc1 L_va_w0
s_waitcnt vmcnt(4)
L_va_w0:
v_smfmac_f32_16x16x64_bf16 v[40:43], v[32:35], v[124:131], v12
buffer_load_dwordx4 v[124:127], v120, s[36:39], s14 offen offset:0 nt
s_waitcnt vmcnt(4)
buffer_load_dwordx4 v[128:131], v120, s[36:39], s14 offen offset:1024 nt
v_and_b32_dpp v32, v44, v10 row_newbcast:4 row_mask:0xf bank_mask:0xf
v_and_b32_dpp v33, v44, v11 row_newbcast:4 row_mask:0xf bank_mask:0xf
v_and_b32_dpp v34, v44, v10 row_newbcast:5 row_mask:0xf bank_mask:0xf
v_and_b32_dpp v35, v44, v11 row_newbcast:5 row_mask:0xf bank_mask:0xf
s_waitcnt vmcnt(5)
s_cmp_gt_u32 s22, 40
s_cbranch_scc1 L_va_w2
s_waitcnt vmcnt(4)
L_va_w2:
v_smfmac_f32_16x16x64_bf16 v[40:43], v[36:39], v[132:139], v12
buffer_load_dwordx4 v[132:135], v121, s[36:39], s14 offen offset:0 nt
s_waitcnt vmcnt(4)
s_cmp_gt_u32 s22, 24
s_cbranch_scc1 L_va_w3
s_waitcnt vmcnt(3)
L_va_w3:
buffer_load_dwordx4 v[136:139], v121, s[36:39], s14 offen offset:1024 nt
v_and_b32_dpp v36, v44, v10 row_newbcast:6 row_mask:0xf bank_mask:0xf
v_and_b32_dpp v37, v44, v11 row_newbcast:6 row_mask:0xf bank_mask:0xf
v_and_b32_dpp v38, v44, v10 row_newbcast:7 row_mask:0xf bank_mask:0xf
v_and_b32_dpp v39, v44, v11 row_newbcast:7 row_mask:0xf bank_mask:0xf
s_waitcnt vmcnt(5)
s_cmp_gt_u32 s22, 36
s_cbranch_scc1 L_va_w4
s_waitcnt vmcnt(4)
L_va_w4:
v_smfmac_f32_16x16x64_bf16 v[40:43], v[32:35], v[140:147], v12
buffer_load_dwordx4 v[140:143], v120, s[36:39], s15 offen offset:0 nt
s_waitcnt vmcnt(4)
buffer_load_dwordx4 v[144:147], v120, s[36:39], s15 offen offset:1024 nt
v_and_b32_dpp v32, v44, v10 row_newbcast:8 row_mask:0xf bank_mask:0xf
v_and_b32_dpp v33, v44, v11 row_newbcast:8 row_mask:0xf bank_mask:0xf
v_and_b32_dpp v34, v44, v10 row_newbcast:9 row_mask:0xf bank_mask:0xf
v_and_b32_dpp v35, v44, v11 row_newbcast:9 row_mask:0xf bank_mask:0xf
s_waitcnt vmcnt(5)
s_cmp_gt_u32 s22, 44
s_cbranch_scc1 L_va_w6
s_waitcnt vmcnt(4)
L_va_w6:
v_smfmac_f32_16x16x64_bf16 v[40:43], v[36:39], v[148:155], v12
buffer_load_dwordx4 v[148:151], v121, s[36:39], s15 offen offset:0 nt
s_waitcnt vmcnt(4)
s_cmp_gt_u32 s22, 28
s_cbranch_scc1 L_va_w7
s_waitcnt vmcnt(3)
L_va_w7:
buffer_load_dwordx4 v[152:155], v121, s[36:39], s15 offen offset:1024 nt
s_cmp_lg_u32 s30, 0
s_cbranch_scc1 L_va_np0
s_add_u32 s68, s35, 1
v_mov_b32 v30, s68
s_mov_b64 exec, 1
buffer_store_dword v30, off, s[48:51], s100
s_mov_b64 exec, -1
L_va_np0:
v_and_b32_dpp v36, v44, v10 row_newbcast:10 row_mask:0xf bank_mask:0xf
v_and_b32_dpp v37, v44, v11 row_newbcast:10 row_mask:0xf bank_mask:0xf
v_and_b32_dpp v38, v44, v10 row_newbcast:11 row_mask:0xf bank_mask:0xf
v_and_b32_dpp v39, v44, v11 row_newbcast:11 row_mask:0xf bank_mask:0xf
s_waitcnt vmcnt(5)
s_cmp_gt_u32 s22, 34
s_cbranch_scc1 L_va_w8
s_waitcnt vmcnt(4)
L_va_w8:
v_smfmac_f32_16x16x64_bf16 v[40:43], v[32:35], v[156:163], v12
buffer_load_dwordx4 v[156:159], v120, s[36:39], s16 offen offset:0 nt
s_waitcnt vmcnt(4)
buffer_load_dwordx4 v[160:163], v120, s[36:39], s16 offen offset:1024 nt
v_and_b32_dpp v32, v44, v10 row_newbcast:12 row_mask:0xf bank_mask:0xf
v_and_b32_dpp v33, v44, v11 row_newbcast:12 row_mask:0xf bank_mask:0xf
v_and_b32_dpp v34, v44, v10 row_newbcast:13 row_mask:0xf bank_mask:0xf
v_and_b32_dpp v35, v44, v11 row_newbcast:13 row_mask:0xf bank_mask:0xf
s_waitcnt vmcnt(5)
s_cmp_gt_u32 s22, 42
s_cbranch_scc1 L_va_w10
s_waitcnt vmcnt(4)
L_va_w10:
v_smfmac_f32_16x16x64_bf16 v[40:43], v[36:39], v[164:171], v12
buffer_load_dwordx4 v[164:167], v121, s[36:39], s16 offen offset:0 nt
s_waitcnt vmcnt(4)
s_cmp_gt_u32 s22, 26
s_cbranch_scc1 L_va_w11
s_waitcnt vmcnt(3)
L_va_w11:
buffer_load_dwordx4 v[168:171], v121, s[36:39], s16 offen offset:1024 nt
v_and_b32_dpp v36, v44, v10 row_newbcast:14 row_mask:0xf bank_mask:0xf
v_and_b32_dpp v37, v44, v11 row_newbcast:14 row_mask:0xf bank_mask:0xf
v_and_b32_dpp v38, v44, v10 row_newbcast:15 row_mask:0xf bank_mask:0xf
v_and_b32_dpp v39, v44, v11 row_newbcast:15 row_mask:0xf bank_mask:0xf
s_waitcnt vmcnt(5)
s_cmp_gt_u32 s22, 38
s_cbranch_scc1 L_va_w12
s_waitcnt vmcnt(4)
L_va_w12:
v_smfmac_f32_16x16x64_bf16 v[40:43], v[32:35], v[172:179], v12
buffer_load_dwordx4 v[172:175], v120, s[36:39], s17 offen offset:0 nt
s_waitcnt vmcnt(4)
buffer_load_dwordx4 v[176:179], v120, s[36:39], s17 offen offset:1024 nt
v_and_b32_dpp v32, v45, v10 row_newbcast:0 row_mask:0xf bank_mask:0xf
v_and_b32_dpp v33, v45, v11 row_newbcast:0 row_mask:0xf bank_mask:0xf
v_and_b32_dpp v34, v45, v10 row_newbcast:1 row_mask:0xf bank_mask:0xf
v_and_b32_dpp v35, v45, v11 row_newbcast:1 row_mask:0xf bank_mask:0xf
s_waitcnt vmcnt(5)
s_cmp_gt_u32 s22, 46
s_cbranch_scc1 L_va_w14
s_waitcnt vmcnt(4)
L_va_w14:
v_smfmac_f32_16x16x64_bf16 v[40:43], v[36:39], v[180:187], v12
buffer_load_dwordx4 v[180:183], v121, s[36:39], s17 offen offset:0 nt
s_waitcnt vmcnt(4)
s_cmp_gt_u32 s22, 30
s_cbranch_scc1 L_va_w15
s_waitcnt vmcnt(3)
L_va_w15:
buffer_load_dwordx4 v[184:187], v121, s[36:39], s17 offen offset:1024 nt
s_cmp_lg_u32 s30, 1
s_cbranch_scc1 L_va_np1
s_add_u32 s68, s35, 2
v_mov_b32 v30, s68
s_mov_b64 exec, 1
buffer_store_dword v30, off, s[48:51], s100
s_mov_b64 exec, -1
L_va_np1:
v_and_b32_dpp v36, v45, v10 row_newbcast:2 row_mask:0xf bank_mask:0xf
v_and_b32_dpp v37, v45, v11 row_newbcast:2 row_mask:0xf bank_mask:0xf
v_and_b32_dpp v38, v45, v10 row_newbcast:3 row_mask:0xf bank_mask:0xf
v_and_b32_dpp v39, v45, v11 row_newbcast:3 row_mask:0xf bank_mask:0xf
v_add_u32_dpp v28, v28, v28 row_ror:8 row_mask:0xf bank_mask:0xf
s_nop 1
v_add_u32_dpp v28, v28, v28 row_ror:4 row_mask:0xf bank_mask:0xf
s_nop 1
v_add_u32_dpp v28, v28, v28 row_ror:2 row_mask:0xf bank_mask:0xf
s_nop 1
v_add_u32_dpp v28, v28, v28 row_ror:1 row_mask:0xf bank_mask:0xf
s_nop 0
v_readlane_b32 s68, v28, 0
v_readlane_b32 s70, v28, 16
v_readlane_b32 s98, v28, 32
v_readlane_b32 s99, v28, 48
s_add_u32 s68, s68, s70
s_add_u32 s98, s98, s99
s_add_u32 s68, s68, s98
s_lshl_b32 s70, s35, 5
s_sub_i32 s68, s68, s70
s_add_i32 s68, s68, 21
s_ashr_i32 s68, s68, 1
s_add_i32 s68, s68, s23
s_max_i32 s68, s68, 24
s_min_i32 s22, s68, 48
L_va_noup:
s_add_u32 s35, s35, 4
s_waitcnt vmcnt(5)
s_cmp_gt_u32 s22, 33
s_cbranch_scc1 L_va_w16
s_waitcnt vmcnt(4)
L_va_w16:
v_smfmac_f32_16x16x64_bf16 v[40:43], v[32:35], v[188:195], v12
buffer_load_dwordx4 v[188:191], v120, s[36:39], s18 offen offset:0 nt
s_waitcnt vmcnt(4)
buffer_load_dwordx4 v[192:195], v120, s[36:39], s18 offen offset:1024 nt
v_and_b32_dpp v32, v45, v10 row_newbcast:4 row_mask:0xf bank_mask:0xf
v_and_b32_dpp v33, v45, v11 row_newbcast:4 row_mask:0xf bank_mask:0xf
v_and_b32_dpp v34, v45, v10 row_newbcast:5 row_mask:0xf bank_mask:0xf
v_and_b32_dpp v35, v45, v11 row_newbcast:5 row_mask:0xf bank_mask:0xf
s_waitcnt vmcnt(5)
s_cmp_gt_u32 s22, 41
s_cbranch_scc1 L_va_w18
s_waitcnt vmcnt(4)
L_va_w18:
v_smfmac_f32_16x16x64_bf16 v[40:43], v[36:39], v[196:203], v12
buffer_load_dwordx4 v[196:199], v121, s[36:39], s18 offen offset:0 nt
s_waitcnt vmcnt(4)
s_cmp_gt_u32 s22, 25
s_cbranch_scc1 L_va_w19
s_waitcnt vmcnt(3)
L_va_w19:
buffer_load_dwordx4 v[200:203], v121, s[36:39], s18 offen offset:1024 nt
v_and_b32_dpp v36, v45, v10 row_newbcast:6 row_mask:0xf bank_mask:0xf
v_and_b32_dpp v37, v45, v11 row_newbcast:6 row_mask:0xf bank_mask:0xf
v_and_b32_dpp v38, v45, v10 row_newbcast:7 row_mask:0xf bank_mask:0xf
v_and_b32_dpp v39, v45, v11 row_newbcast:7 row_mask:0xf bank_mask:0xf
s_waitcnt vmcnt(5)
s_cmp_gt_u32 s22, 37
s_cbranch_scc1 L_va_w20
s_waitcnt vmcnt(4)
L_va_w20:
v_smfmac_f32_16x16x64_bf16 v[40:43], v[32:35], v[204:211], v12
buffer_load_dwordx4 v[204:207], v120, s[36:39], s19 offen offset:0 nt
s_waitcnt vmcnt(4)
buffer_load_dwordx4 v[208:211], v120, s[36:39], s19 offen offset:1024 nt
v_and_b32_dpp v32, v45, v10 row_newbcast:8 row_mask:0xf bank_mask:0xf
v_and_b32_dpp v33, v45, v11 row_newbcast:8 row_mask:0xf bank_mask:0xf
v_and_b32_dpp v34, v45, v10 row_newbcast:9 row_mask:0xf bank_mask:0xf
v_and_b32_dpp v35, v45, v11 row_newbcast:9 row_mask:0xf bank_mask:0xf
s_waitcnt vmcnt(5)
s_cmp_gt_u32 s22, 45
s_cbranch_scc1 L_va_w22
s_waitcnt vmcnt(4)
L_va_w22:
v_smfmac_f32_16x16x64_bf16 v[40:43], v[36:39], v[212:219], v12
buffer_load_dwordx4 v[212:215], v121, s[36:39], s19 offen offset:0 nt
s_waitcnt vmcnt(4)
s_cmp_gt_u32 s22, 29
s_cbranch_scc1 L_va_w23
s_waitcnt vmcnt(3)
L_va_w23:
buffer_load_dwordx4 v[216:219], v121, s[36:39], s19 offen offset:1024 nt
s_cmp_lg_u32 s30, 2
s_cbranch_scc1 L_va_np2
s_add_u32 s68, s35, -1
v_mov_b32 v30, s68
s_mov_b64 exec, 1
buffer_store_dword v30, off, s[48:51], s100
s_mov_b64 exec, -1
L_va_np2:
v_and_b32_dpp v36, v45, v10 row_newbcast:10 row_mask:0xf bank_mask:0xf
v_and_b32_dpp v37, v45, v11 row_newbcast:10 row_mask:0xf bank_mask:0xf
v_and_b32_dpp v38, v45, v10 row_newbcast:11 row_mask:0xf bank_mask:0xf
v_and_b32_dpp v39, v45, v11 row_newbcast:11 row_mask:0xf bank_mask:0xf
s_waitcnt vmcnt(5)
s_cmp_gt_u32 s22, 35
s_cbranch_scc1 L_va_w24
s_waitcnt vmcnt(4)
L_va_w24:
v_smfmac_f32_16x16x64_bf16 v[40:43], v[32:35], v[220:227], v12
buffer_load_dwordx4 v[220:223], v120, s[36:39], s20 offen offset:0 nt
s_waitcnt vmcnt(4)
buffer_load_dwordx4 v[224:227], v120, s[36:39], s20 offen offset:1024 nt
v_and_b32_dpp v32, v45, v10 row_newbcast:12 row_mask:0xf bank_mask:0xf
v_and_b32_dpp v33, v45, v11 row_newbcast:12 row_mask:0xf bank_mask:0xf
v_and_b32_dpp v34, v45, v10 row_newbcast:13 row_mask:0xf bank_mask:0xf
v_and_b32_dpp v35, v45, v11 row_newbcast:13 row_mask:0xf bank_mask:0xf
s_waitcnt vmcnt(5)
s_cmp_gt_u32 s22, 43
s_cbranch_scc1 L_va_w26
s_waitcnt vmcnt(4)
L_va_w26:
v_smfmac_f32_16x16x64_bf16 v[40:43], v[36:39], v[228:235], v12
buffer_load_dwordx4 v[228:231], v121, s[36:39], s20 offen offset:0 nt
s_waitcnt vmcnt(4)
s_cmp_gt_u32 s22, 27
s_cbranch_scc1 L_va_w27
s_waitcnt vmcnt(3)
L_va_w27:
buffer_load_dwordx4 v[232:235], v121, s[36:39], s20 offen offset:1024 nt
v_and_b32_dpp v36, v45, v10 row_newbcast:14 row_mask:0xf bank_mask:0xf
v_and_b32_dpp v37, v45, v11 row_newbcast:14 row_mask:0xf bank_mask:0xf
v_and_b32_dpp v38, v45, v10 row_newbcast:15 row_mask:0xf bank_mask:0xf
v_and_b32_dpp v39, v45, v11 row_newbcast:15 row_mask:0xf bank_mask:0xf
s_waitcnt vmcnt(5)
s_cmp_gt_u32 s22, 39
s_cbranch_scc1 L_va_w28
s_waitcnt vmcnt(4)
L_va_w28:
v_smfmac_f32_16x16x64_bf16 v[40:43], v[32:35], v[236:243], v12
buffer_load_dwordx4 v[236:239], v120, s[36:39], s21 offen offset:0 nt
s_waitcnt vmcnt(4)
buffer_load_dwordx4 v[240:243], v120, s[36:39], s21 offen offset:1024 nt
s_nop 0
s_waitcnt vmcnt(5)
s_cmp_gt_u32 s22, 47
s_cbranch_scc1 L_va_w30
s_waitcnt vmcnt(4)
L_va_w30:
v_smfmac_f32_16x16x64_bf16 v[40:43], v[36:39], v[244:251], v12
buffer_load_dwordx4 v[244:247], v121, s[36:39], s21 offen offset:0 nt
s_waitcnt vmcnt(4)
s_cmp_gt_u32 s22, 31
s_cbranch_scc1 L_va_w31
s_waitcnt vmcnt(3)
L_va_w31:
buffer_load_dwordx4 v[248:251], v121, s[36:39], s21 offen offset:1024 nt
s_cmp_lg_u32 s30, 3
s_cbranch_scc1 L_va_np3
s_add_u32 s68, s35, 0
v_mov_b32 v30, s68
s_mov_b64 exec, 1
buffer_store_dword v30, off, s[48:51], s100
s_mov_b64 exec, -1
L_va_np3:
s_cmp_lt_u32 s66, 6
s_cbranch_scc1 L_va
L_vb:
s_add_u32 s67, s67, 131072
s_waitcnt lgkmcnt(0)
v_mov_b32 v44, v46
v_mov_b32 v45, v47
v_fma_f32 v6, v48, v4, -v5
v_fma_f32 v7, v49, v4, -v5
v_add_u32 v13, 512, v13
v_exp_f32 v6, v6
v_exp_f32 v7, v7
ds_read_b32 v48, v13 offset:0
ds_read_b32 v49, v13 offset:256
v_cvt_pk_bf16_f32 v46, v6, v6
v_cvt_pk_bf16_f32 v47, v7, v7
v_add_f32 v24, v24, v6
v_add_f32 v24, v24, v7
s_mov_b32 s14, s67
s_add_u32 s15, s67, 16384
s_add_u32 s16, s67, 32768
s_add_u32 s17, s67, 49152
s_add_u32 s18, s67, 65536
s_add_u32 s19, s67, 81920
s_add_u32 s20, s67, 98304
s_add_u32 s21, s67, 114688
s_add_u32 s66, s66, 1
s_cmp_lg_u32 s66, 7
s_cbranch_scc1 L_vb_go
v_add_f32_dpp v24, v24, v24 row_ror:8 row_mask:0xf bank_mask:0xf
s_nop 1
v_add_f32_dpp v24, v24, v24 row_ror:4 row_mask:0xf bank_mask:0xf
s_nop 1
v_add_f32_dpp v24, v24, v24 row_ror:2 row_mask:0xf bank_mask:0xf
s_nop 1
v_add_f32_dpp v24, v24, v24 row_ror:1 row_mask:0xf bank_mask:0xf
s_nop 0
v_mov_b32 v6, v24
s_nop 1
v_permlane16_swap_b32 v24, v6
s_nop 0
v_add_f32 v24, v24, v6
v_mov_b32 v6, v24
s_nop 1
v_permlane32_swap_b32 v24, v6
s_nop 0
v_add_f32 v24, v24, v6
s_lshl_b32 s68, s30, 3
v_mov_b32 v8, v5
v_mov_b32 v9, v24
v_mov_b32 v7, s68
ds_write_b64 v7, v[8:9] offset:4096
L_vb_go:
v_and_b32_dpp v32, v44, v10 row_newbcast:0 row_mask:0xf bank_mask:0xf
v_and_b32_dpp v33, v44, v11 row_newbcast:0 row_mask:0xf bank_mask:0xf
v_and_b32_dpp v34, v44, v10 row_newbcast:1 row_mask:0xf bank_mask:0xf
v_and_b32_dpp v35, v44, v11 row_newbcast:1 row_mask:0xf bank_mask:0xf
v_and_b32_dpp v36, v44, v10 row_newbcast:2 row_mask:0xf bank_mask:0xf
v_and_b32_dpp v37, v44, v11 row_newbcast:2 row_mask:0xf bank_mask:0xf
v_and_b32_dpp v38, v44, v10 row_newbcast:3 row_mask:0xf bank_mask:0xf
v_and_b32_dpp v39, v44, v11 row_newbcast:3 row_mask:0xf bank_mask:0xf
s_waitcnt vmcnt(15)
v_smfmac_f32_16x16x64_bf16 v[40:43], v[32:35], v[124:131], v12
buffer_load_dwordx4 v[124:127], v120, s[36:39], s14 offen offset:0 nt
s_waitcnt vmcnt(15)
buffer_load_dwordx4 v[128:131], v120, s[36:39], s14 offen offset:1024 nt
v_and_b32_dpp v32, v44, v10 row_newbcast:4 row_mask:0xf bank_mask:0xf
v_and_b32_dpp v33, v44, v11 row_newbcast:4 row_mask:0xf bank_mask:0xf
v_and_b32_dpp v34, v44, v10 row_newbcast:5 row_mask:0xf bank_mask:0xf
v_and_b32_dpp v35, v44, v11 row_newbcast:5 row_mask:0xf bank_mask:0xf
s_waitcnt vmcnt(15)
v_smfmac_f32_16x16x64_bf16 v[40:43], v[36:39], v[132:139], v12
buffer_load_dwordx4 v[132:135], v121, s[36:39], s14 offen offset:0 nt
s_waitcnt vmcnt(15)
buffer_load_dwordx4 v[136:139], v121, s[36:39], s14 offen offset:1024 nt
v_and_b32_dpp v36, v44, v10 row_newbcast:6 row_mask:0xf bank_mask:0xf
v_and_b32_dpp v37, v44, v11 row_newbcast:6 row_mask:0xf bank_mask:0xf
v_and_b32_dpp v38, v44, v10 row_newbcast:7 row_mask:0xf bank_mask:0xf
v_and_b32_dpp v39, v44, v11 row_newbcast:7 row_mask:0xf bank_mask:0xf
s_waitcnt vmcnt(15)
v_smfmac_f32_16x16x64_bf16 v[40:43], v[32:35], v[140:147], v12
buffer_load_dwordx4 v[140:143], v120, s[36:39], s15 offen offset:0 nt
s_waitcnt vmcnt(15)
buffer_load_dwordx4 v[144:147], v120, s[36:39], s15 offen offset:1024 nt
v_and_b32_dpp v32, v44, v10 row_newbcast:8 row_mask:0xf bank_mask:0xf
v_and_b32_dpp v33, v44, v11 row_newbcast:8 row_mask:0xf bank_mask:0xf
v_and_b32_dpp v34, v44, v10 row_newbcast:9 row_mask:0xf bank_mask:0xf
v_and_b32_dpp v35, v44, v11 row_newbcast:9 row_mask:0xf bank_mask:0xf
s_waitcnt vmcnt(15)
v_smfmac_f32_16x16x64_bf16 v[40:43], v[36:39], v[148:155], v12
buffer_load_dwordx4 v[148:151], v121, s[36:39], s15 offen offset:0 nt
s_waitcnt vmcnt(15)
buffer_load_dwordx4 v[152:155], v121, s[36:39], s15 offen offset:1024 nt
v_and_b32_dpp v36, v44, v10 row_newbcast:10 row_mask:0xf bank_mask:0xf
v_and_b32_dpp v37, v44, v11 row_newbcast:10 row_mask:0xf bank_mask:0xf
v_and_b32_dpp v38, v44, v10 row_newbcast:11 row_mask:0xf bank_mask:0xf
v_and_b32_dpp v39, v44, v11 row_newbcast:11 row_mask:0xf bank_mask:0xf
s_waitcnt vmcnt(15)
v_smfmac_f32_16x16x64_bf16 v[40:43], v[32:35], v[156:163], v12
buffer_load_dwordx4 v[156:159], v120, s[36:39], s16 offen offset:0 nt
s_waitcnt vmcnt(15)
buffer_load_dwordx4 v[160:163], v120, s[36:39], s16 offen offset:1024 nt
v_and_b32_dpp v32, v44, v10 row_newbcast:12 row_mask:0xf bank_mask:0xf
v_and_b32_dpp v33, v44, v11 row_newbcast:12 row_mask:0xf bank_mask:0xf
v_and_b32_dpp v34, v44, v10 row_newbcast:13 row_mask:0xf bank_mask:0xf
v_and_b32_dpp v35, v44, v11 row_newbcast:13 row_mask:0xf bank_mask:0xf
s_waitcnt vmcnt(15)
v_smfmac_f32_16x16x64_bf16 v[40:43], v[36:39], v[164:171], v12
buffer_load_dwordx4 v[164:167], v121, s[36:39], s16 offen offset:0 nt
s_waitcnt vmcnt(15)
buffer_load_dwordx4 v[168:171], v121, s[36:39], s16 offen offset:1024 nt
v_and_b32_dpp v36, v44, v10 row_newbcast:14 row_mask:0xf bank_mask:0xf
v_and_b32_dpp v37, v44, v11 row_newbcast:14 row_mask:0xf bank_mask:0xf
v_and_b32_dpp v38, v44, v10 row_newbcast:15 row_mask:0xf bank_mask:0xf
v_and_b32_dpp v39, v44, v11 row_newbcast:15 row_mask:0xf bank_mask:0xf
s_waitcnt vmcnt(15)
v_smfmac_f32_16x16x64_bf16 v[40:43], v[32:35], v[172:179], v12
buffer_load_dwordx4 v[172:175], v120, s[36:39], s17 offen offset:0 nt
s_waitcnt vmcnt(15)
buffer_load_dwordx4 v[176:179], v120, s[36:39], s17 offen offset:1024 nt
v_and_b32_dpp v32, v45, v10 row_newbcast:0 row_mask:0xf bank_mask:0xf
v_and_b32_dpp v33, v45, v11 row_newbcast:0 row_mask:0xf bank_mask:0xf
v_and_b32_dpp v34, v45, v10 row_newbcast:1 row_mask:0xf bank_mask:0xf
v_and_b32_dpp v35, v45, v11 row_newbcast:1 row_mask:0xf bank_mask:0xf
s_waitcnt vmcnt(15)
v_smfmac_f32_16x16x64_bf16 v[40:43], v[36:39], v[180:187], v12
buffer_load_dwordx4 v[180:183], v121, s[36:39], s17 offen offset:0 nt
s_waitcnt vmcnt(15)
buffer_load_dwordx4 v[184:187], v121, s[36:39], s17 offen offset:1024 nt
v_and_b32_dpp v36, v45, v10 row_newbcast:2 row_mask:0xf bank_mask:0xf
v_and_b32_dpp v37, v45, v11 row_newbcast:2 row_mask:0xf bank_mask:0xf
v_and_b32_dpp v38, v45, v10 row_newbcast:3 row_mask:0xf bank_mask:0xf
v_and_b32_dpp v39, v45, v11 row_newbcast:3 row_mask:0xf bank_mask:0xf
s_waitcnt vmcnt(15)
v_smfmac_f32_16x16x64_bf16 v[40:43], v[32:35], v[188:195], v12
buffer_load_dwordx4 v[188:191], v120, s[36:39], s18 offen offset:0 nt
s_waitcnt vmcnt(15)
buffer_load_dwordx4 v[192:195], v120, s[36:39], s18 offen offset:1024 nt
v_and_b32_dpp v32, v45, v10 row_newbcast:4 row_mask:0xf bank_mask:0xf
v_and_b32_dpp v33, v45, v11 row_newbcast:4 row_mask:0xf bank_mask:0xf
v_and_b32_dpp v34, v45, v10 row_newbcast:5 row_mask:0xf bank_mask:0xf
v_and_b32_dpp v35, v45, v11 row_newbcast:5 row_mask:0xf bank_mask:0xf
s_waitcnt vmcnt(15)
v_smfmac_f32_16x16x64_bf16 v[40:43], v[36:39], v[196:203], v12
buffer_load_dwordx4 v[196:199], v121, s[36:39], s18 offen offset:0 nt
s_waitcnt vmcnt(15)
buffer_load_dwordx4 v[200:203], v121, s[36:39], s18 offen offset:1024 nt
v_and_b32_dpp v36, v45, v10 row_newbcast:6 row_mask:0xf bank_mask:0xf
v_and_b32_dpp v37, v45, v11 row_newbcast:6 row_mask:0xf bank_mask:0xf
v_and_b32_dpp v38, v45, v10 row_newbcast:7 row_mask:0xf bank_mask:0xf
v_and_b32_dpp v39, v45, v11 row_newbcast:7 row_mask:0xf bank_mask:0xf
s_waitcnt vmcnt(15)
v_smfmac_f32_16x16x64_bf16 v[40:43], v[32:35], v[204:211], v12
buffer_load_dwordx4 v[204:207], v120, s[36:39], s19 offen offset:0 nt
s_waitcnt vmcnt(15)
buffer_load_dwordx4 v[208:211], v120, s[36:39], s19 offen offset:1024 nt
v_and_b32_dpp v32, v45, v10 row_newbcast:8 row_mask:0xf bank_mask:0xf
v_and_b32_dpp v33, v45, v11 row_newbcast:8 row_mask:0xf bank_mask:0xf
v_and_b32_dpp v34, v45, v10 row_newbcast:9 row_mask:0xf bank_mask:0xf
v_and_b32_dpp v35, v45, v11 row_newbcast:9 row_mask:0xf bank_mask:0xf
s_waitcnt vmcnt(15)
v_smfmac_f32_16x16x64_bf16 v[40:43], v[36:39], v[212:219], v12
buffer_load_dwordx4 v[212:215], v121, s[36:39], s19 offen offset:0 nt
s_waitcnt vmcnt(15)
buffer_load_dwordx4 v[216:219], v121, s[36:39], s19 offen offset:1024 nt
v_and_b32_dpp v36, v45, v10 row_newbcast:10 row_mask:0xf bank_mask:0xf
v_and_b32_dpp v37, v45, v11 row_newbcast:10 row_mask:0xf bank_mask:0xf
v_and_b32_dpp v38, v45, v10 row_newbcast:11 row_mask:0xf bank_mask:0xf
v_and_b32_dpp v39, v45, v11 row_newbcast:11 row_mask:0xf bank_mask:0xf
s_waitcnt vmcnt(15)
v_smfmac_f32_16x16x64_bf16 v[40:43], v[32:35], v[220:227], v12
buffer_load_dwordx4 v[220:223], v120, s[36:39], s20 offen offset:0 nt
s_waitcnt vmcnt(15)
buffer_load_dwordx4 v[224:227], v120, s[36:39], s20 offen offset:1024 nt
v_and_b32_dpp v32, v45, v10 row_newbcast:12 row_mask:0xf bank_mask:0xf
v_and_b32_dpp v33, v45, v11 row_newbcast:12 row_mask:0xf bank_mask:0xf
v_and_b32_dpp v34, v45, v10 row_newbcast:13 row_mask:0xf bank_mask:0xf
v_and_b32_dpp v35, v45, v11 row_newbcast:13 row_mask:0xf bank_mask:0xf
s_waitcnt vmcnt(15)
v_smfmac_f32_16x16x64_bf16 v[40:43], v[36:39], v[228:235], v12
buffer_load_dwordx4 v[228:231], v121, s[36:39], s20 offen offset:0 nt
s_waitcnt vmcnt(15)
buffer_load_dwordx4 v[232:235], v121, s[36:39], s20 offen offset:1024 nt
v_and_b32_dpp v36, v45, v10 row_newbcast:14 row_mask:0xf bank_mask:0xf
v_and_b32_dpp v37, v45, v11 row_newbcast:14 row_mask:0xf bank_mask:0xf
v_and_b32_dpp v38, v45, v10 row_newbcast:15 row_mask:0xf bank_mask:0xf
v_and_b32_dpp v39, v45, v11 row_newbcast:15 row_mask:0xf bank_mask:0xf
s_waitcnt vmcnt(15)
v_smfmac_f32_16x16x64_bf16 v[40:43], v[32:35], v[236:243], v12
buffer_load_dwordx4 v[236:239], v120, s[36:39], s21 offen offset:0 nt
s_waitcnt vmcnt(15)
buffer_load_dwordx4 v[240:243], v120, s[36:39], s21 offen offset:1024 nt
s_nop 0
s_waitcnt vmcnt(15)
v_smfmac_f32_16x16x64_bf16 v[40:43], v[36:39], v[244:251], v12
buffer_load_dwordx4 v[244:247], v121, s[36:39], s21 offen offset:0 nt
s_waitcnt vmcnt(15)
buffer_load_dwordx4 v[248:251], v121, s[36:39], s21 offen offset:1024 nt
v_mov_b32 v6, 0
v_mov_b32 v44, v46
v_mov_b32 v45, v47
s_waitcnt lgkmcnt(0)
s_barrier
ds_read_b128 v[112:115], v6 offset:4096
ds_read_b128 v[116:119], v6 offset:4112
s_mov_b32 s70, 0xffffff00
s_waitcnt lgkmcnt(0)
v_max3_f32 v6, v112, v114, v116
v_max_f32 v6, v6, v118
v_sub_f32 v112, v112, v6
v_sub_f32 v114, v114, v6
v_sub_f32 v116, v116, v6
v_sub_f32 v118, v118, v6
v_exp_f32 v112, v112
v_exp_f32 v114, v114
v_exp_f32 v116, v116
v_exp_f32 v118, v118
s_nop 0
v_mul_f32 v6, v112, v113
v_fmac_f32 v6, v114, v115
v_fmac_f32 v6, v116, v117
v_fmac_f32 v6, v118, v119
v_rcp_f32 v6, v6
s_nop 0
v_mul_f32 v56, v112, v6
v_mul_f32 v57, v114, v6
v_mul_f32 v58, v116, v6
v_mul_f32 v59, v118, v6
v_and_b32_dpp v32, v44, v10 row_newbcast:0 row_mask:0xf bank_mask:0xf
v_and_b32_dpp v33, v44, v11 row_newbcast:0 row_mask:0xf bank_mask:0xf
v_and_b32_dpp v34, v44, v10 row_newbcast:1 row_mask:0xf bank_mask:0xf
v_and_b32_dpp v35, v44, v11 row_newbcast:1 row_mask:0xf bank_mask:0xf
v_and_b32_dpp v36, v44, v10 row_newbcast:2 row_mask:0xf bank_mask:0xf
v_and_b32_dpp v37, v44, v11 row_newbcast:2 row_mask:0xf bank_mask:0xf
v_and_b32_dpp v38, v44, v10 row_newbcast:3 row_mask:0xf bank_mask:0xf
v_and_b32_dpp v39, v44, v11 row_newbcast:3 row_mask:0xf bank_mask:0xf
s_waitcnt vmcnt(30)
v_smfmac_f32_16x16x64_bf16 v[40:43], v[32:35], v[124:131], v12
s_nop 1
v_and_b32_dpp v32, v44, v10 row_newbcast:4 row_mask:0xf bank_mask:0xf
v_and_b32_dpp v33, v44, v11 row_newbcast:4 row_mask:0xf bank_mask:0xf
v_and_b32_dpp v34, v44, v10 row_newbcast:5 row_mask:0xf bank_mask:0xf
v_and_b32_dpp v35, v44, v11 row_newbcast:5 row_mask:0xf bank_mask:0xf
s_waitcnt vmcnt(28)
v_smfmac_f32_16x16x64_bf16 v[40:43], v[36:39], v[132:139], v12
s_nop 1
v_and_b32_dpp v36, v44, v10 row_newbcast:6 row_mask:0xf bank_mask:0xf
v_and_b32_dpp v37, v44, v11 row_newbcast:6 row_mask:0xf bank_mask:0xf
v_and_b32_dpp v38, v44, v10 row_newbcast:7 row_mask:0xf bank_mask:0xf
v_and_b32_dpp v39, v44, v11 row_newbcast:7 row_mask:0xf bank_mask:0xf
s_waitcnt vmcnt(26)
v_smfmac_f32_16x16x64_bf16 v[40:43], v[32:35], v[140:147], v12
s_nop 1
v_and_b32_dpp v32, v44, v10 row_newbcast:8 row_mask:0xf bank_mask:0xf
v_and_b32_dpp v33, v44, v11 row_newbcast:8 row_mask:0xf bank_mask:0xf
v_and_b32_dpp v34, v44, v10 row_newbcast:9 row_mask:0xf bank_mask:0xf
v_and_b32_dpp v35, v44, v11 row_newbcast:9 row_mask:0xf bank_mask:0xf
s_waitcnt vmcnt(24)
v_smfmac_f32_16x16x64_bf16 v[40:43], v[36:39], v[148:155], v12
s_nop 1
v_and_b32_dpp v36, v44, v10 row_newbcast:10 row_mask:0xf bank_mask:0xf
v_and_b32_dpp v37, v44, v11 row_newbcast:10 row_mask:0xf bank_mask:0xf
v_and_b32_dpp v38, v44, v10 row_newbcast:11 row_mask:0xf bank_mask:0xf
v_and_b32_dpp v39, v44, v11 row_newbcast:11 row_mask:0xf bank_mask:0xf
s_waitcnt vmcnt(22)
v_smfmac_f32_16x16x64_bf16 v[40:43], v[32:35], v[156:163], v12
s_nop 1
v_and_b32_dpp v32, v44, v10 row_newbcast:12 row_mask:0xf bank_mask:0xf
v_and_b32_dpp v33, v44, v11 row_newbcast:12 row_mask:0xf bank_mask:0xf
v_and_b32_dpp v34, v44, v10 row_newbcast:13 row_mask:0xf bank_mask:0xf
v_and_b32_dpp v35, v44, v11 row_newbcast:13 row_mask:0xf bank_mask:0xf
s_waitcnt vmcnt(20)
v_smfmac_f32_16x16x64_bf16 v[40:43], v[36:39], v[164:171], v12
s_nop 1
v_and_b32_dpp v36, v44, v10 row_newbcast:14 row_mask:0xf bank_mask:0xf
v_and_b32_dpp v37, v44, v11 row_newbcast:14 row_mask:0xf bank_mask:0xf
v_and_b32_dpp v38, v44, v10 row_newbcast:15 row_mask:0xf bank_mask:0xf
v_and_b32_dpp v39, v44, v11 row_newbcast:15 row_mask:0xf bank_mask:0xf
s_waitcnt vmcnt(18)
v_smfmac_f32_16x16x64_bf16 v[40:43], v[32:35], v[172:179], v12
s_nop 1
v_and_b32_dpp v32, v45, v10 row_newbcast:0 row_mask:0xf bank_mask:0xf
v_and_b32_dpp v33, v45, v11 row_newbcast:0 row_mask:0xf bank_mask:0xf
v_and_b32_dpp v34, v45, v10 row_newbcast:1 row_mask:0xf bank_mask:0xf
v_and_b32_dpp v35, v45, v11 row_newbcast:1 row_mask:0xf bank_mask:0xf
s_waitcnt vmcnt(16)
v_smfmac_f32_16x16x64_bf16 v[40:43], v[36:39], v[180:187], v12
s_nop 1
v_and_b32_dpp v36, v45, v10 row_newbcast:2 row_mask:0xf bank_mask:0xf
v_and_b32_dpp v37, v45, v11 row_newbcast:2 row_mask:0xf bank_mask:0xf
v_and_b32_dpp v38, v45, v10 row_newbcast:3 row_mask:0xf bank_mask:0xf
v_and_b32_dpp v39, v45, v11 row_newbcast:3 row_mask:0xf bank_mask:0xf
s_waitcnt vmcnt(14)
v_smfmac_f32_16x16x64_bf16 v[40:43], v[32:35], v[188:195], v12
s_nop 1
v_and_b32_dpp v32, v45, v10 row_newbcast:4 row_mask:0xf bank_mask:0xf
v_and_b32_dpp v33, v45, v11 row_newbcast:4 row_mask:0xf bank_mask:0xf
v_and_b32_dpp v34, v45, v10 row_newbcast:5 row_mask:0xf bank_mask:0xf
v_and_b32_dpp v35, v45, v11 row_newbcast:5 row_mask:0xf bank_mask:0xf
s_waitcnt vmcnt(12)
v_smfmac_f32_16x16x64_bf16 v[40:43], v[36:39], v[196:203], v12
s_nop 1
v_and_b32_dpp v36, v45, v10 row_newbcast:6 row_mask:0xf bank_mask:0xf
v_and_b32_dpp v37, v45, v11 row_newbcast:6 row_mask:0xf bank_mask:0xf
v_and_b32_dpp v38, v45, v10 row_newbcast:7 row_mask:0xf bank_mask:0xf
v_and_b32_dpp v39, v45, v11 row_newbcast:7 row_mask:0xf bank_mask:0xf
s_waitcnt vmcnt(10)
v_smfmac_f32_16x16x64_bf16 v[40:43], v[32:35], v[204:211], v12
s_nop 1
v_and_b32_dpp v32, v45, v10 row_newbcast:8 row_mask:0xf bank_mask:0xf
v_and_b32_dpp v33, v45, v11 row_newbcast:8 row_mask:0xf bank_mask:0xf
v_and_b32_dpp v34, v45, v10 row_newbcast:9 row_mask:0xf bank_mask:0xf
v_and_b32_dpp v35, v45, v11 row_newbcast:9 row_mask:0xf bank_mask:0xf
s_waitcnt vmcnt(8)
v_smfmac_f32_16x16x64_bf16 v[40:43], v[36:39], v[212:219], v12
s_nop 1
v_and_b32_dpp v36, v45, v10 row_newbcast:10 row_mask:0xf bank_mask:0xf
v_and_b32_dpp v37, v45, v11 row_newbcast:10 row_mask:0xf bank_mask:0xf
v_and_b32_dpp v38, v45, v10 row_newbcast:11 row_mask:0xf bank_mask:0xf
v_and_b32_dpp v39, v45, v11 row_newbcast:11 row_mask:0xf bank_mask:0xf
s_waitcnt vmcnt(6)
v_smfmac_f32_16x16x64_bf16 v[40:43], v[32:35], v[220:227], v12
s_nop 1
v_and_b32_dpp v32, v45, v10 row_newbcast:12 row_mask:0xf bank_mask:0xf
v_and_b32_dpp v33, v45, v11 row_newbcast:12 row_mask:0xf bank_mask:0xf
v_and_b32_dpp v34, v45, v10 row_newbcast:13 row_mask:0xf bank_mask:0xf
v_and_b32_dpp v35, v45, v11 row_newbcast:13 row_mask:0xf bank_mask:0xf
s_waitcnt vmcnt(4)
v_smfmac_f32_16x16x64_bf16 v[40:43], v[36:39], v[228:235], v12
s_nop 1
v_and_b32_dpp v36, v45, v10 row_newbcast:14 row_mask:0xf bank_mask:0xf
v_and_b32_dpp v37, v45, v11 row_newbcast:14 row_mask:0xf bank_mask:0xf
v_and_b32_dpp v38, v45, v10 row_newbcast:15 row_mask:0xf bank_mask:0xf
v_and_b32_dpp v39, v45, v11 row_newbcast:15 row_mask:0xf bank_mask:0xf
s_waitcnt vmcnt(2)
v_smfmac_f32_16x16x64_bf16 v[40:43], v[32:35], v[236:243], v12
s_nop 0
s_waitcnt vmcnt(0)
v_smfmac_f32_16x16x64_bf16 v[40:43], v[36:39], v[244:251], v12
s_nop 7
s_mov_b32 exec_hi, 0
ds_write_b128 v27, v[40:43] offset:2048
s_mov_b32 exec_hi, -1
s_waitcnt lgkmcnt(0)
s_barrier
ds_read_b32 v80, v252 offset:2048
ds_read_b32 v81, v252 offset:2560
ds_read_b32 v82, v252 offset:3072
ds_read_b32 v83, v252 offset:3584
s_waitcnt lgkmcnt(2)
v_mul_f32 v80, v80, v56
v_fmac_f32 v80, v81, v57
s_waitcnt lgkmcnt(0)
v_fmac_f32 v80, v82, v58
v_fmac_f32 v80, v83, v59
v_cvt_pk_bf16_f32 v44, v80, v80
s_nop 1
v_and_b32_dpp v32, v44, v10 row_newbcast:0 row_mask:0xf bank_mask:0xf
v_and_b32_dpp v33, v44, v11 row_newbcast:0 row_mask:0xf bank_mask:0xf
v_and_b32_dpp v34, v44, v10 row_newbcast:1 row_mask:0xf bank_mask:0xf
v_and_b32_dpp v35, v44, v11 row_newbcast:1 row_mask:0xf bank_mask:0xf
s_nop 1
v_smfmac_f32_16x16x64_bf16 a[160:163], v[32:35], a[0:7], v12
v_smfmac_f32_16x16x64_bf16 a[164:167], v[32:35], a[8:15], v12
v_and_b32_dpp v36, v44, v10 row_newbcast:2 row_mask:0xf bank_mask:0xf
v_and_b32_dpp v37, v44, v11 row_newbcast:2 row_mask:0xf bank_mask:0xf
v_and_b32_dpp v38, v44, v10 row_newbcast:3 row_mask:0xf bank_mask:0xf
v_and_b32_dpp v39, v44, v11 row_newbcast:3 row_mask:0xf bank_mask:0xf
v_smfmac_f32_16x16x64_bf16 a[168:171], v[32:35], a[16:23], v12
v_smfmac_f32_16x16x64_bf16 a[172:175], v[32:35], a[24:31], v12
v_smfmac_f32_16x16x64_bf16 a[176:179], v[32:35], a[32:39], v12
v_smfmac_f32_16x16x64_bf16 a[160:163], v[36:39], a[40:47], v12
v_smfmac_f32_16x16x64_bf16 a[164:167], v[36:39], a[48:55], v12
v_and_b32_dpp v32, v44, v10 row_newbcast:4 row_mask:0xf bank_mask:0xf
v_and_b32_dpp v33, v44, v11 row_newbcast:4 row_mask:0xf bank_mask:0xf
v_and_b32_dpp v34, v44, v10 row_newbcast:5 row_mask:0xf bank_mask:0xf
v_and_b32_dpp v35, v44, v11 row_newbcast:5 row_mask:0xf bank_mask:0xf
v_smfmac_f32_16x16x64_bf16 a[168:171], v[36:39], a[56:63], v12
v_smfmac_f32_16x16x64_bf16 a[172:175], v[36:39], a[64:71], v12
v_smfmac_f32_16x16x64_bf16 a[176:179], v[36:39], a[72:79], v12
v_smfmac_f32_16x16x64_bf16 a[160:163], v[32:35], a[80:87], v12
v_smfmac_f32_16x16x64_bf16 a[164:167], v[32:35], a[88:95], v12
v_and_b32_dpp v36, v44, v10 row_newbcast:6 row_mask:0xf bank_mask:0xf
v_and_b32_dpp v37, v44, v11 row_newbcast:6 row_mask:0xf bank_mask:0xf
v_and_b32_dpp v38, v44, v10 row_newbcast:7 row_mask:0xf bank_mask:0xf
v_and_b32_dpp v39, v44, v11 row_newbcast:7 row_mask:0xf bank_mask:0xf
v_smfmac_f32_16x16x64_bf16 a[168:171], v[32:35], a[96:103], v12
v_smfmac_f32_16x16x64_bf16 a[172:175], v[32:35], a[104:111], v12
v_smfmac_f32_16x16x64_bf16 a[176:179], v[32:35], a[112:119], v12
v_smfmac_f32_16x16x64_bf16 a[160:163], v[36:39], a[120:127], v12
v_smfmac_f32_16x16x64_bf16 a[164:167], v[36:39], a[128:135], v12
v_smfmac_f32_16x16x64_bf16 a[168:171], v[36:39], a[136:143], v12
v_smfmac_f32_16x16x64_bf16 a[172:175], v[36:39], a[144:151], v12
v_smfmac_f32_16x16x64_bf16 a[176:179], v[36:39], a[152:159], v12
s_mov_b32 exec_hi, 0
s_nop 3
ds_write_b128 v253, a[160:163] offset:4224
ds_write_b128 v253, a[164:167] offset:4736
ds_write_b128 v253, a[168:171] offset:5248
ds_write_b128 v253, a[172:175] offset:5760
ds_write_b128 v253, a[176:179] offset:6272
s_mov_b32 exec_hi, -1
s_waitcnt lgkmcnt(0)
s_barrier
s_cmp_eq_u32 s30, 3
s_cbranch_scc1 L_consume
ds_read_b128 v[80:83], v254 offset:4224
ds_read_b128 v[84:87], v254 offset:6784
ds_read_b128 v[88:91], v254 offset:9344
ds_read_b128 v[92:95], v254 offset:11904
s_waitcnt lgkmcnt(2)
v_pk_add_f32 v[80:81], v[80:81], v[84:85]
v_pk_add_f32 v[82:83], v[82:83], v[86:87]
s_waitcnt lgkmcnt(0)
v_pk_add_f32 v[88:89], v[88:89], v[92:93]
v_pk_add_f32 v[90:91], v[90:91], v[94:95]
v_pk_add_f32 v[80:81], v[80:81], v[88:89]
v_pk_add_f32 v[82:83], v[82:83], v[90:91]
v_and_or_b32 v80, v80, s70, v52
v_and_or_b32 v81, v81, s70, v53
v_and_or_b32 v82, v82, s70, v54
v_and_or_b32 v83, v83, s70, v55
buffer_store_dwordx4 v[80:83], v255, s[52:55], s69 offen sc0 sc1
s_cmp_lg_u32 s30, 0
s_cbranch_scc1 L_nodone
s_waitcnt vmcnt(0)
v_mov_b32 v30, 100
s_mov_b64 exec, 1
buffer_store_dword v30, off, s[48:51], s100
s_mov_b64 exec, -1
L_nodone:
s_branch L_fin
L_consume:
s_cmp_eq_u32 s71, 0
s_cbranch_scc1 L_fin
s_lshl_b32 s68, s31, 12
s_mov_b32 s72, 0
v_mov_b32 v8, 0x0c0c0400
v_mov_b32 v9, 0x04000c0c
s_mul_i32 s66, s32, 2560
s_mul_i32 s69, s33, 1280
s_add_u32 s66, s66, s69
s_lshl_b32 s69, s31, 6
s_add_u32 s66, s66, s69
v_and_b32 v22, 7, v1
v_lshrrev_b32 v6, 4, v1
v_lshlrev_b32 v6, 1, v6
v_lshl_add_u32 v22, v22, 3, v6
s_mov_b32 s98, 0
L_hold:
buffer_load_dword v28, v29, s[48:51], 0 offen sc1
s_add_u32 s98, s98, 1
s_waitcnt vmcnt(0)
v_cmp_eq_u32 vcc, 100, v28
s_cmp_ge_u32 s98, 12
s_cbranch_scc1 L_held
s_bcnt1_i32_b64 s99, vcc
s_cmp_lt_u32 s99, 28
s_cbranch_scc1 L_hold
L_held:
L_poll:
buffer_load_dwordx4 v[80:83], v2, s[52:55], s68 offen offset:0 sc0 sc1
buffer_load_dwordx4 v[84:87], v2, s[52:55], s68 offen offset:1024 sc0 sc1
buffer_load_dwordx4 v[88:91], v2, s[52:55], s68 offen offset:2048 sc0 sc1
buffer_load_dwordx4 v[92:95], v2, s[52:55], s68 offen offset:3072 sc0 sc1
s_add_u32 s72, s72, 1
s_waitcnt vmcnt(3)
v_perm_b32 v6, v81, v80, v8
v_perm_b32 v7, v83, v82, v9
v_and_b32 v80, s70, v80
v_and_b32 v81, s70, v81
v_and_b32 v82, s70, v82
v_and_b32 v83, s70, v83
v_or_b32 v6, v6, v7
v_xor_b32 v96, v6, v25
s_waitcnt vmcnt(2)
v_perm_b32 v6, v85, v84, v8
v_perm_b32 v7, v87, v86, v9
v_and_b32 v84, s70, v84
v_and_b32 v85, s70, v85
v_and_b32 v86, s70, v86
v_and_b32 v87, s70, v87
v_or_b32 v6, v6, v7
v_xor_b32 v97, v6, v25
v_pk_add_f32 v[80:81], v[80:81], v[84:85]
v_pk_add_f32 v[82:83], v[82:83], v[86:87]
s_waitcnt vmcnt(1)
v_perm_b32 v6, v89, v88, v8
v_perm_b32 v7, v91, v90, v9
v_and_b32 v88, s70, v88
v_and_b32 v89, s70, v89
v_and_b32 v90, s70, v90
v_and_b32 v91, s70, v91
v_or_b32 v6, v6, v7
v_xor_b32 v98, v6, v25
s_waitcnt vmcnt(0)
v_perm_b32 v6, v93, v92, v8
v_perm_b32 v7, v95, v94, v9
v_and_b32 v92, s70, v92
v_and_b32 v93, s70, v93
v_and_b32 v94, s70, v94
v_and_b32 v95, s70, v95
v_or_b32 v6, v6, v7
v_xor_b32 v99, v6, v25
v_or3_b32 v6, v96, v97, v98
v_or_b32 v6, v6, v99
v_cmp_ne_u32 vcc, 0, v6
v_pk_add_f32 v[88:89], v[88:89], v[92:93]
v_pk_add_f32 v[90:91], v[90:91], v[94:95]
v_pk_add_f32 v[80:81], v[80:81], v[88:89]
v_pk_add_f32 v[82:83], v[82:83], v[90:91]
s_cmp_ge_u32 s72, 0x200000
s_cbranch_scc1 L_polled
s_cbranch_vccnz L_poll
L_polled:
s_mov_b32 s74, 0x00ff00ff
s_mov_b32 s75, 0x00ff00ff
v_permlane16_swap_b32 v80, v81
v_permlane16_swap_b32 v82, v83
s_nop 0
v_add_f32 v80, v80, v81
v_add_f32 v82, v82, v83
s_nop 1
v_permlane32_swap_b32 v80, v82
s_nop 0
v_add_f32 v80, v80, v82
s_nop 1
v_add_f32_dpp v80, v80, v80 row_ror:8 row_mask:0xf bank_mask:0xf
v_cvt_pk_bf16_f32 v80, v80, v80
s_mov_b64 exec, s[74:75]
buffer_store_short v80, v22, s[60:63], s66 offen
s_cmp_lg_u32 s31, 0
s_cbranch_scc1 L_nobump
s_mov_b64 exec, 1
buffer_store_dword v25, off, s[56:59], 0
L_nobump:
s_mov_b64 exec, -1
L_fin:
L_end:
s_endpgm
.section .rodata,"a"
.p2align 6
.amdhsa_kernel concat_heads__gqa_block_cached__gqa_block_cached__decode_kernel
  .amdhsa_next_free_vgpr 436
  .amdhsa_next_free_sgpr 102
  .amdhsa_accum_offset 256
  .amdhsa_group_segment_fixed_size 0
  .amdhsa_kernarg_size 104
  .amdhsa_user_sgpr_count 2
  .amdhsa_user_sgpr_kernarg_segment_ptr 1
  .amdhsa_system_sgpr_workgroup_id_x 1
  .amdhsa_float_denorm_mode_32 3
.end_amdhsa_kernel
```
